```python
import torch

def _softmax(x, axis=-1):
    return torch.softmax(x, dim=axis)
def _gelu(x):
    return torch.nn.functional.gelu(x, approximate="tanh")
def _silu(x):
    return torch.nn.functional.silu(x)
def _sigmoid(x):
    return torch.sigmoid(x)
def _layernorm(x, axis=-1, eps=1e-5):
    m = x.mean(dim=axis, keepdim=True)
    v = x.var(dim=axis, keepdim=True, unbiased=False)
    return (x - m) / torch.sqrt(v + eps)
def _scatter_add(tgt, idx, src, axis=0):
    return tgt.clone().index_add_(axis, idx, src)
def _segment_sum(src, seg, n):
    out = torch.zeros((n,) + src.shape[1:], dtype=src.dtype)
    return out.index_add_(0, seg, src)
def _pad(x, pw):
    flat = tuple(v for pair in reversed(pw) for v in pair)
    return torch.nn.functional.pad(x, flat)

kernel_name = 'gated_mix__spectral_fnet__softmax_full_mha__prompt'

def setup_inputs():

    _w = (lambda a: (lambda t: t.to(torch.bfloat16) if t.is_floating_point() else t)(torch.as_tensor(a)))
    def _A_setup():
        B, S, D = 1, 2048, 640
        ns = torch.arange(S)[:, None] * torch.arange(S)[None, :]
        nd = torch.arange(D)[:, None] * torch.arange(D)[None, :]
        Ws_re = torch.cos(-2.0 * torch.pi * ns / S).to(float)
        Ws_im = torch.sin(-2.0 * torch.pi * ns / S).to(float)
        Wd_re = torch.cos(-2.0 * torch.pi * nd / D).to(float)
        Wd_im = torch.sin(-2.0 * torch.pi * nd / D).to(float)
        return {
            "x": _w((lambda *s: torch.randn(*s, dtype=torch.bfloat16) * 0.05)(B, S, D)),
            "dft_seq_re": _w(Ws_re),
            "dft_seq_im": _w(Ws_im),
            "dft_hid_re": _w(Wd_re),
            "dft_hid_im": _w(Wd_im),
        }
    _A_in = _A_setup()

    def _B_setup():
        B, S, D = 1, 2048, 640
        return {
            "x": _w((lambda *s: torch.randn(*s, dtype=torch.bfloat16) * 0.05)(B, S, D)),
            "wqkv": _w((lambda *s: torch.randn(*s, dtype=torch.bfloat16) * 1.6)(D, 3 * D)),
            "wo": _w((lambda *s: torch.randn(*s, dtype=torch.bfloat16) * 1.6)(D, D)),
        }
    _B_in = _B_setup()

    return {
        "A_x": _A_in["x"],
        "A_dft_seq_re": _A_in["dft_seq_re"],
        "A_dft_seq_im": _A_in["dft_seq_im"],
        "A_dft_hid_re": _A_in["dft_hid_re"],
        "A_dft_hid_im": _A_in["dft_hid_im"],
        "B_x": _B_in["x"],
        "B_wqkv": _B_in["wqkv"],
        "B_wo": _B_in["wo"],
        "gate_w": _w((lambda *s: torch.randn(*s, dtype=torch.bfloat16) * 0.05)(640) * 16.0),
    }

def reference(A_x, A_dft_seq_re, A_dft_seq_im, A_dft_hid_re, A_dft_hid_im, B_x, B_wqkv, B_wo, gate_w):
    def _A_ref(x, dft_seq_re, dft_seq_im, dft_hid_re, dft_hid_im):
        a = torch.einsum("bsd,ed->bse", x, dft_hid_re)
        b = torch.einsum("bsd,ed->bse", x, dft_hid_im)
        y = torch.einsum("ts,bse->bte", dft_seq_re, a) - torch.einsum("ts,bse->bte", dft_seq_im, b)
        return y

    def _B_ref(x, wqkv, wo):
        B, S, D = x.shape
        H = 32; Dh = D // H
        qkv = (lambda x, *d: x.permute(*d))((x @ wqkv).reshape(B, S, 3, H, Dh), 2, 0, 3, 1, 4)
        q, k, v = qkv[0], qkv[1], qkv[2]
        scale = Dh ** -0.5
        scores = torch.einsum("bhqd,bhkd->bhqk", q, k) * scale
        p = _softmax(scores, axis=-1)
        o = torch.einsum("bhqk,bhkd->bhqd", p, v)
        return (lambda x, *d: x.permute(*d))(o, 0, 2, 1, 3).reshape(B, S, D) @ wo

    x = A_x
    g = _sigmoid((x * gate_w).sum(-1, keepdims=True))
    a = _A_ref(x, A_dft_seq_re, A_dft_seq_im, A_dft_hid_re, A_dft_hid_im)
    b = _B_ref(x, B_wqkv, B_wo)
    return g * a + (1 - g) * b
```

```asm
; @launch grid=(256,1,1) block=(768,1,1) lds=163840
.amdgcn_target "amdgcn-amd-amdhsa--gfx950"
.text
.p2align 8
.globl gated_mix__spectral_fnet__softmax_full_mha__prompt_kernel
.type gated_mix__spectral_fnet__softmax_full_mha__prompt_kernel,@function
gated_mix__spectral_fnet__softmax_full_mha__prompt_kernel:
    s_cmp_ge_u32 s2, 256
    s_cbranch_scc1 L_END
    s_load_dwordx2 s[4:5], s[0:1], 0
    s_load_dwordx8 s[48:55], s[0:1], 48
    s_load_dwordx4 s[8:11], s[0:1], 24
    s_load_dwordx4 s[56:59], s[0:1], 80
    v_lshrrev_b32 v1, 6, v0
    v_and_b32 v0, 63, v0
    s_and_b32 s17, s2, 7
    v_readfirstlane_b32 s16, v1
    s_lshr_b32 s18, s2, 3
    s_and_b32 s19, s18, 7
    s_lshr_b32 s22, s18, 3
    s_and_b32 s21, s17, 1
    s_lshl_b32 s23, s19, 1
    s_add_u32 s21, s21, s23
    s_lshr_b32 s20, s17, 1
    s_cmp_ge_u32 s19, 4
    s_cselect_b32 s12, 1, 0
    s_cmp_eq_u32 s22, 0
    s_cselect_b32 s12, 0, s12
    s_cmp_ge_u32 s16, 4
    s_cbranch_scc1 P1_NOTLOADER
    s_setprio 3
    v_lshrrev_b32 v2, 3, v0
    v_and_b32 v3, 7, v0
    v_lshrrev_b32 v4, 4, v0
    v_xor_b32 v3, v3, v4
    v_lshlrev_b32 v3, 4, v3
    v_xor_b32 v4, 64, v3
    s_lshl_b32 s23, s21, 5
    s_lshr_b32 s24, s16, 1
    s_lshl_b32 s24, s24, 4
    s_add_u32 s23, s23, s24
    s_cmp_eq_u32 s22, 2
    s_cselect_b32 s25, 4, 0
    v_and_b32 v9, s25, v2
    v_add3_u32 v9, v9, v2, s23
    s_sub_u32 s25, 8, s25
    s_bitcmp1_b32 s16, 0
    s_cselect_b32 s23, -1, 1
    s_cselect_b32 s24, 0x400, 0
    s_mul_i32 s25, s25, s23
    v_mul_lo_u32 v10, v9, s23
    s_sub_u32 s27, 0x800, s24
    v_add_u32 v5, s24, v10
    v_sub_u32 v7, s27, v10
    v_add_u32 v6, s25, v5
    v_subrev_u32 v8, s25, v7
    v_cmp_eq_u32 vcc, 0, v9
    s_add_u32 s24, s24, 0x200
    v_mov_b32 v9, s24
    s_cmp_lg_u32 s22, 2
    v_cndmask_b32 v7, v7, v9, vcc
    s_cbranch_scc1 P1_LD_NV
    v_swap_b32 v6, v7
P1_LD_NV:
    s_movk_i32 s27, 1280
    v_mad_u32_u24 v10, v5, s27, v3
    v_mad_u32_u24 v11, v6, s27, v4
    v_mad_u32_u24 v12, v7, s27, v3
    v_mad_u32_u24 v13, v8, s27, v4
    s_lshr_b32 s36, s17, 1
    s_xor_b32 s36, s36, s17
    s_and_b32 s36, s36, 1
    s_xor_b32 s36, s36, 9
    s_lshl_b32 s41, s36, 7
    s_lshl_b32 s44, s16, 12
    s_add_u32 m0, s44, 84992
    s_waitcnt lgkmcnt(0)
    s_mov_b32 s28, s4
    s_mov_b32 s29, s5
    s_mov_b32 s30, 2621440
    s_mov_b32 s31, 0x20000
    buffer_load_dwordx4 v10, s[28:31], s41 offen lds
    s_add_u32 m0, s44, 86016
    s_nop 0
    buffer_load_dwordx4 v11, s[28:31], s41 offen lds
    s_add_u32 m0, s44, 87040
    s_nop 0
    buffer_load_dwordx4 v12, s[28:31], s41 offen lds
    s_add_u32 m0, s44, 88064
    s_nop 0
    buffer_load_dwordx4 v13, s[28:31], s41 offen lds
    s_lshl_b32 s26, s22, 2
    s_add_u32 s26, s26, s20
    s_and_b32 s27, s20, 1
    s_movk_i32 s25, 3840
    s_cmp_eq_u32 s22, 3
    s_cselect_b32 s25, 1280, s25
    s_cselect_b32 s26, s27, s26
    s_mul_i32 s26, s26, 320
    s_lshl_b32 s27, s16, 4
    s_mul_i32 s27, s27, s25
    s_add_u32 s26, s26, s27
    s_sub_u32 s27, s25, 320
    v_add_u32 v5, 0, v0
    v_mul_u32_u24 v6, 3277, v5
    v_lshrrev_b32 v6, 16, v6
    v_lshrrev_b32 v7, 2, v6
    v_and_b32 v7, 2, v7
    v_xor_b32 v5, v5, v7
    v_lshl_add_u32 v5, v5, 4, s26
    v_mad_u32_u24 v14, v6, s27, v5
    v_add_u32 v5, 64, v0
    v_mul_u32_u24 v6, 3277, v5
    v_lshrrev_b32 v6, 16, v6
    v_lshrrev_b32 v7, 2, v6
    v_and_b32 v7, 2, v7
    v_xor_b32 v5, v5, v7
    v_lshl_add_u32 v5, v5, 4, s26
    v_mad_u32_u24 v15, v6, s27, v5
    v_add_u32 v5, 128, v0
    v_mul_u32_u24 v6, 3277, v5
    v_lshrrev_b32 v6, 16, v6
    v_lshrrev_b32 v7, 2, v6
    v_and_b32 v7, 2, v7
    v_xor_b32 v5, v5, v7
    v_lshl_add_u32 v5, v5, 4, s26
    v_mad_u32_u24 v16, v6, s27, v5
    v_add_u32 v5, 192, v0
    v_mul_u32_u24 v6, 3277, v5
    v_lshrrev_b32 v6, 16, v6
    v_lshrrev_b32 v7, 2, v6
    v_and_b32 v7, 2, v7
    v_xor_b32 v5, v5, v7
    v_lshl_add_u32 v5, v5, 4, s26
    v_mad_u32_u24 v17, v6, s27, v5
    v_add_u32 v5, 256, v0
    v_mul_u32_u24 v6, 3277, v5
    v_lshrrev_b32 v6, 16, v6
    v_lshrrev_b32 v7, 2, v6
    v_and_b32 v7, 2, v7
    v_xor_b32 v5, v5, v7
    v_lshl_add_u32 v5, v5, 4, s26
    v_mad_u32_u24 v18, v6, s27, v5
    s_lshr_b32 s36, s17, 1
    s_xor_b32 s36, s36, s17
    s_and_b32 s36, s36, 1
    s_lshr_b32 s37, s22, 0
    s_add_u32 s37, s37, s19
    s_lshr_b32 s46, s17, 2
    s_lshl_b32 s46, s46, 1
    s_add_u32 s37, s37, s46
    s_mul_i32 s46, s37, 52
    s_lshr_b32 s46, s46, 8
    s_mul_i32 s46, s46, 5
    s_sub_u32 s37, s37, s46
    s_lshl_b32 s37, s37, 2
    s_mov_b32 s46, 0x42086420
    s_mov_b32 s47, 0x6
    s_lshr_b64 s[46:47], s[46:47], s37
    s_and_b32 s46, s46, 0xfffff
    s_or_b32 s46, s46, 0x53100000
    s_mov_b32 s47, 0x97
    s_mul_i32 s37, s36, 0x11111111
    s_xor_b32 s46, s46, s37
    s_xor_b32 s47, s47, s37
    s_lshr_b32 s37, s47, 4
    s_and_b32 s37, s37, 15
    s_lshl_b64 s[46:47], s[46:47], 4
    s_or_b32 s46, s46, s37
    s_and_b32 s36, s46, 15
    s_lshl_b32 s38, s16, 12
    s_add_u32 s38, s38, 11264
    s_mul_i32 s39, s16, 5120
    s_add_u32 s39, s39, 27648
    s_mov_b32 s40, 0
    s_mul_i32 s34, s25, 640
    s_lshl_b32 s25, s25, 6
    s_mov_b32 s35, 0x20000
    s_waitcnt lgkmcnt(0)
    s_mov_b32 s28, s4
    s_mov_b32 s29, s5
    s_mov_b32 s30, 2621440
    s_mov_b32 s31, 0x20000
    s_cmp_lt_u32 s20, 2
    s_cselect_b32 s32, s8, s10
    s_cselect_b32 s33, s9, s11
    s_cmp_eq_u32 s22, 3
    s_cselect_b32 s32, s32, s48
    s_cselect_b32 s33, s33, s49
P1_LD_LOOP:
    s_lshl_b32 s41, s36, 7
    s_mul_i32 s42, s36, s25
    s_add_u32 s43, s40, 2
    s_and_b32 s43, s43, 3
    s_mul_i32 s43, s43, 36864
    s_add_u32 s44, s43, s38
    s_add_u32 s45, s43, s39
    s_cmp_eq_u32 s40, 0
    s_cbranch_scc1 P1_LD_WW
    s_add_u32 m0, s44, 0
    s_nop 0
    buffer_load_dwordx4 v10, s[28:31], s41 offen lds
    s_add_u32 m0, s44, 1024
    s_nop 0
    buffer_load_dwordx4 v11, s[28:31], s41 offen lds
    s_add_u32 m0, s44, 2048
    s_nop 0
    buffer_load_dwordx4 v12, s[28:31], s41 offen lds
    s_add_u32 m0, s44, 3072
    s_nop 0
    buffer_load_dwordx4 v13, s[28:31], s41 offen lds
P1_LD_WW:
    s_add_u32 m0, s45, 0
    s_nop 0
    buffer_load_dwordx4 v14, s[32:35], s42 offen lds
    s_add_u32 m0, s45, 1024
    s_nop 0
    buffer_load_dwordx4 v15, s[32:35], s42 offen lds
    s_add_u32 m0, s45, 2048
    s_nop 0
    buffer_load_dwordx4 v16, s[32:35], s42 offen lds
    s_add_u32 m0, s45, 3072
    s_nop 0
    buffer_load_dwordx4 v17, s[32:35], s42 offen lds
    s_add_u32 m0, s45, 4096
    s_nop 0
    buffer_load_dwordx4 v18, s[32:35], s42 offen lds
    s_lshr_b64 s[46:47], s[46:47], 4
    s_and_b32 s36, s46, 15
    s_add_u32 s40, s40, 1
    s_cmp_eq_u32 s40, 1
    s_cbranch_scc1 P1_LD_LOOP
    s_waitcnt vmcnt(9)
    s_barrier
    s_cmp_lt_u32 s40, 10
    s_cbranch_scc1 P1_LD_LOOP
    s_waitcnt vmcnt(0)
    s_barrier
    s_branch HELPER
P1_NOTLOADER:
    s_lshl_b32 s63, s17, 2
    s_add_u32 s63, s63, s22
    s_mul_i32 s14, s63, 164352
    s_sub_u32 s13, s16, 4
    s_lshl_b32 s23, s19, 3
    s_add_u32 s23, s23, s13
    s_mul_i32 s23, s23, 40960
    s_add_u32 s23, s23, 12914688
    s_lshl_b32 s6, s63, 9
    s_add_u32 s6, s6, s23
    s_lshl_b32 s7, s63, 7
    s_add_u32 s7, s7, s23
    s_add_u32 s7, s7, 16384
    s_lshl_b32 s15, s20, 2
    s_add_u32 s15, s15, s22
    s_lshl_b32 s15, s15, 4
    s_add_u32 s15, s15, s21
    s_lshl_b32 s15, s15, 5
    s_add_u32 s15, s15, s13
    s_lshl_b32 s15, s15, 2
    s_add_u32 s15, s15, 15536128
    v_and_b32 v1, 31, v0
    v_lshrrev_b32 v2, 5, v0
    v_lshlrev_b32 v152, 4, v0
    v_lshrrev_b32 v3, 4, v1
    v_lshl_add_u32 v3, v3, 1, v2
    v_and_b32 v4, 15, v0
    v_lshl_add_u32 v3, v4, 2, v3
    v_lshlrev_b32 v153, 2, v3
    v_mul_u32_u24 v154, 384, v2
    v_lshlrev_b32 v3, 6, v2
    v_cmp_gt_u32 vcc, 16, v1
    s_nop 1
    v_cndmask_b32 v154, v3, v154, vcc
    v_lshl_add_u32 v154, v1, 4, v154
    v_add_u32 v155, 15360, v152
    v_add_u32 v156, 15360, v153
    v_add_u32 v157, 15360, v154
    v_cmp_eq_u32 vcc, 20, v1
    v_mov_b32 v3, 0x3f803f80
    v_bfe_u32 v159, v1, 3, 1
    v_cndmask_b32 v160, 0, v3, vcc
    v_mul_u32_u24 v159, 20480, v159
    v_and_b32 v3, 7, v1
    v_lshl_add_u32 v159, v3, 4, v159
    v_lshrrev_b32 v3, 4, v0
    v_lshl_add_u32 v158, v3, 7, v159
    s_lshl_b32 s23, s13, 2
    s_add_u32 s23, s23, 158720
    v_mov_b32 v161, s23
    v_mov_b32 v162, 158776
    v_lshlrev_b32 v163, 4, v0
    v_and_b32 v2, 7, v0
    v_bfe_u32 v4, v0, 3, 1
    v_lshrrev_b32 v3, 4, v0
    v_lshlrev_b32 v164, 8, v3
    v_lshl_add_u32 v164, v2, 4, v164
    v_lshl_add_u32 v164, v4, 3, v164
    v_bfe_u32 v2, v0, 2, 2
    v_and_b32 v5, 3, v0
    v_mul_u32_u24 v5, 40, v5
    v_mul_u32_u24 v4, 40, v3
    v_add3_u32 v4, v4, v2, 16
    v_mul_u32_u24 v4, 160, v4
    v_add_u32 v166, v4, v5
    v_lshrrev_b32 v4, 1, v3
    v_mul_u32_u24 v4, 20, v4
    v_and_b32 v3, 1, v3
    v_lshl_add_u32 v4, v3, 2, v4
    v_add_u32 v4, v4, v2
    v_mul_u32_u24 v4, 160, v4
    v_add_u32 v165, v4, v5
    s_cmp_ge_u32 s16, 8
    s_cbranch_scc1 P1_EXTRA
    s_sub_u32 s61, s16, 4
    s_and_b32 s36, s61, 1
    s_lshr_b32 s37, s61, 1
    v_mov_b32 v150, v0
    v_and_b32 v1, 15, v0
    v_lshrrev_b32 v2, 4, v0
    v_lshrrev_b32 v3, 1, v1
    v_xor_b32 v3, v3, v2
    v_lshlrev_b32 v3, 4, v3
    v_lshl_add_u32 v3, v1, 7, v3
    s_lshl_b32 s23, s36, 13
    s_add_u32 s23, s23, 11264
    v_add_u32 v136, s23, v3
    v_bfe_u32 v3, v0, 2, 2
    v_lshl_add_u32 v3, v2, 3, v3
    v_mul_u32_u24 v3, 320, v3
    v_add_u32 v3, 27648, v3
    v_and_b32 v4, 16, v0
    v_lshlrev_b32 v4, 1, v4
    v_and_b32 v5, 3, v0
    s_mul_i32 s23, s37, 160
    v_lshl_add_u32 v6, v5, 3, s23
    v_xor_b32 v7, v6, v4
    v_add_u32 v137, v7, v3
    v_add_u32 v6, 40, v6
    v_xor_b32 v7, v6, v4
    v_add_u32 v138, v7, v3
    v_add_u32 v6, 40, v6
    v_xor_b32 v7, v6, v4
    v_add_u32 v139, v7, v3
    v_add_u32 v6, 40, v6
    v_xor_b32 v7, v6, v4
    v_add_u32 v140, v7, v3
    v_add_u32 v6, 40, v6
    v_mul_u32_u24 v6, 40, v5
    v_add3_u32 v6, v6, s23, 32
    v_xor_b32 v7, v6, v4
    v_add_u32 v141, v7, v3
    v_mov_b32 v149, 0xbf803f80
    s_lshl_b32 s26, s22, 2
    s_add_u32 s26, s26, s20
    s_lshl_b32 s26, s26, 1
    s_add_u32 s26, s26, s37
    s_cmp_eq_u32 s26, 28
    s_cselect_b32 s24, 0x10001, 0
    s_mov_b32 s25, s24
    s_cmp_eq_u32 s22, 3
    s_cselect_b32 s43, 10, 8
    s_mov_b32 s40, 0
    s_mov_b32 s42, 73728
    v_mov_b32 v0, 0
    v_mov_b32 v1, 0
    v_mov_b32 v2, 0
    v_mov_b32 v3, 0
    v_mov_b32 v4, 0
    v_mov_b32 v5, 0
    v_mov_b32 v6, 0
    v_mov_b32 v7, 0
    v_mov_b32 v8, 0
    v_mov_b32 v9, 0
    v_mov_b32 v10, 0
    v_mov_b32 v11, 0
    v_mov_b32 v12, 0
    v_mov_b32 v13, 0
    v_mov_b32 v14, 0
    v_mov_b32 v15, 0
    v_mov_b32 v16, 0
    v_mov_b32 v17, 0
    v_mov_b32 v18, 0
    v_mov_b32 v19, 0
    v_mov_b32 v20, 0
    v_mov_b32 v21, 0
    v_mov_b32 v22, 0
    v_mov_b32 v23, 0
    v_mov_b32 v24, 0
    v_mov_b32 v25, 0
    v_mov_b32 v26, 0
    v_mov_b32 v27, 0
    v_mov_b32 v28, 0
    v_mov_b32 v29, 0
    v_mov_b32 v30, 0
    v_mov_b32 v31, 0
    v_mov_b32 v32, 0
    v_mov_b32 v33, 0
    v_mov_b32 v34, 0
    v_mov_b32 v35, 0
    v_mov_b32 v36, 0
    v_mov_b32 v37, 0
    v_mov_b32 v38, 0
    v_mov_b32 v39, 0
    v_mov_b32 v40, 0
    v_mov_b32 v41, 0
    v_mov_b32 v42, 0
    v_mov_b32 v43, 0
    v_mov_b32 v44, 0
    v_mov_b32 v45, 0
    v_mov_b32 v46, 0
    v_mov_b32 v47, 0
    v_mov_b32 v48, 0
    v_mov_b32 v49, 0
    v_mov_b32 v50, 0
    v_mov_b32 v51, 0
    v_mov_b32 v52, 0
    v_mov_b32 v53, 0
    v_mov_b32 v54, 0
    v_mov_b32 v55, 0
    v_mov_b32 v56, 0
    v_mov_b32 v57, 0
    v_mov_b32 v58, 0
    v_mov_b32 v59, 0
    v_mov_b32 v60, 0
    v_mov_b32 v61, 0
    v_mov_b32 v62, 0
    v_mov_b32 v63, 0
    v_mov_b32 v64, 0
    v_mov_b32 v65, 0
    v_mov_b32 v66, 0
    v_mov_b32 v67, 0
    v_mov_b32 v68, 0
    v_mov_b32 v69, 0
    v_mov_b32 v70, 0
    v_mov_b32 v71, 0
    v_mov_b32 v72, 0
    v_mov_b32 v73, 0
    v_mov_b32 v74, 0
    v_mov_b32 v75, 0
    v_mov_b32 v76, 0
    v_mov_b32 v77, 0
    v_mov_b32 v78, 0
    v_mov_b32 v79, 0
    v_mov_b32 v80, 0
    v_mov_b32 v81, 0
    v_mov_b32 v82, 0
    v_mov_b32 v83, 0
    v_mov_b32 v84, 0
    v_mov_b32 v85, 0
    v_mov_b32 v86, 0
    v_mov_b32 v87, 0
    v_mov_b32 v88, 0
    v_mov_b32 v89, 0
    v_mov_b32 v90, 0
    v_mov_b32 v91, 0
    v_mov_b32 v92, 0
    v_mov_b32 v93, 0
    v_mov_b32 v94, 0
    v_mov_b32 v95, 0
    v_mov_b32 v116, 0
    v_mov_b32 v117, 0
    v_mov_b32 v118, 0
    v_mov_b32 v119, 0
    v_mov_b32 v120, 0
    v_mov_b32 v121, 0
    v_mov_b32 v122, 0
    v_mov_b32 v123, 0
    v_mov_b32 v124, 0
    v_mov_b32 v125, 0
    v_mov_b32 v126, 0
    v_mov_b32 v127, 0
    v_mov_b32 v128, 0
    v_mov_b32 v129, 0
    v_mov_b32 v130, 0
    v_mov_b32 v131, 0
    v_mov_b32 v132, 0
    v_mov_b32 v133, 0
    v_mov_b32 v134, 0
    v_mov_b32 v135, 0
    v_add_u32 v142, s42, v136
    v_add_u32 v144, s42, v137
    v_add_u32 v145, s42, v138
    v_add_u32 v146, s42, v139
    v_add_u32 v147, s42, v140
    v_add_u32 v148, s42, v141
    s_waitcnt lgkmcnt(0)
    s_mov_b32 s28, s58
    s_mov_b32 s29, s59
    s_mov_b32 s30, 15577088
    s_mov_b32 s31, 0x20000
    s_setprio 2
    s_cmp_ge_u32 s22, 2
    s_cbranch_scc1 P1_PRE_V
P1_PRE_QK:
    s_mov_b32 s35, 164352
    s_movk_i32 s38, 2560
    s_cmp_eq_u32 s22, 0
    s_cselect_b32 s35, 82432, s35
    s_cselect_b32 s27, 5259264, 0
    s_cselect_b32 s38, 1280, s38
    s_lshl_b32 s26, s20, 1
    s_add_u32 s26, s26, s37
    s_lshl_b32 s26, s26, 2
    s_mul_i32 s26, s26, s35
    s_add_u32 s26, s26, s27
    s_lshl_b32 s23, s21, 1
    s_add_u32 s23, s23, s36
    s_lshl_b32 s23, s23, 1
    s_mul_i32 s23, s23, s38
    s_add_u32 s26, s26, s23
    s_add_u32 s27, s26, s38
    v_lshrrev_b32 v167, 4, v150
    v_mul_lo_u32 v167, v167, s35
    v_and_b32 v96, 15, v150
    v_lshl_add_u32 v167, v96, 4, v167
    v_lshlrev_b32 v151, 4, v150
    s_add_u32 s44, s26, s35
    s_add_u32 s45, s27, s35
    s_add_u32 s46, s44, s35
    s_add_u32 s47, s45, s35
    s_add_u32 s32, s46, s35
    s_add_u32 s33, s47, s35
P1_LOOP_QK:
    s_waitcnt lgkmcnt(2)
    v_mfma_f32_16x16x32_bf16 v[4:7], v[120:123], v[80:83], v[4:7]
    v_xor_b32 v143, 64, v142
    v_mfma_f32_16x16x32_bf16 v[8:11], v[124:127], v[80:83], v[8:11]
    s_barrier
    v_mfma_f32_16x16x32_bf16 v[12:15], v[128:131], v[80:83], v[12:15]
    ds_read_b64_tr_b16 v[100:101], v145 offset:0
    v_mfma_f32_16x16x32_bf16 v[16:19], v[132:135], v[80:83], v[16:19]
    ds_read_b64_tr_b16 v[102:103], v145 offset:1280
    v_mfma_f32_16x16x32_bf16 v[0:3], v[116:119], v[80:83], v[0:3]
    ds_read_b128 v[80:83], v142 offset:0
    v_mfma_f32_16x16x32_bf16 v[24:27], v[120:123], v[84:87], v[24:27]
    ds_read_b64_tr_b16 v[104:105], v146 offset:0
    v_mfma_f32_16x16x32_bf16 v[28:31], v[124:127], v[84:87], v[28:31]
    ds_read_b64_tr_b16 v[106:107], v146 offset:1280
    v_mfma_f32_16x16x32_bf16 v[32:35], v[128:131], v[84:87], v[32:35]
    ds_read_b64_tr_b16 v[108:109], v147 offset:0
    v_mfma_f32_16x16x32_bf16 v[36:39], v[132:135], v[84:87], v[36:39]
    ds_read_b64_tr_b16 v[110:111], v147 offset:1280
    v_mfma_f32_16x16x32_bf16 v[20:23], v[116:119], v[84:87], v[20:23]
    ds_read_b128 v[84:87], v142 offset:2048
    s_waitcnt lgkmcnt(9)
    v_mfma_f32_16x16x32_bf16 v[44:47], v[120:123], v[88:91], v[44:47]
    ds_read_b64_tr_b16 v[112:113], v148 offset:0
    v_mfma_f32_16x16x32_bf16 v[48:51], v[124:127], v[88:91], v[48:51]
    ds_read_b64_tr_b16 v[114:115], v148 offset:1280
    v_mfma_f32_16x16x32_bf16 v[52:55], v[128:131], v[88:91], v[52:55]
    ds_read_b64_tr_b16 v[96:97], v144 offset:0
    v_mfma_f32_16x16x32_bf16 v[56:59], v[132:135], v[88:91], v[56:59]
    ds_read_b64_tr_b16 v[98:99], v144 offset:1280
    v_mfma_f32_16x16x32_bf16 v[40:43], v[116:119], v[88:91], v[40:43]
    ds_read_b128 v[88:91], v142 offset:4096
    s_waitcnt lgkmcnt(13)
    v_mfma_f32_16x16x32_bf16 v[64:67], v[120:123], v[92:95], v[64:67]
    v_mfma_f32_16x16x32_bf16 v[68:71], v[124:127], v[92:95], v[68:71]
    v_mfma_f32_16x16x32_bf16 v[72:75], v[128:131], v[92:95], v[72:75]
    v_mfma_f32_16x16x32_bf16 v[76:79], v[132:135], v[92:95], v[76:79]
    v_mfma_f32_16x16x32_bf16 v[60:63], v[116:119], v[92:95], v[60:63]
    ds_read_b128 v[92:95], v142 offset:6144
    s_waitcnt lgkmcnt(2)
    v_mfma_f32_16x16x32_bf16 v[4:7], v[100:103], v[80:83], v[4:7]
    ds_read_b64_tr_b16 v[120:121], v145 offset:10240
    v_mfma_f32_16x16x32_bf16 v[8:11], v[104:107], v[80:83], v[8:11]
    ds_read_b64_tr_b16 v[122:123], v145 offset:11520
    v_mfma_f32_16x16x32_bf16 v[12:15], v[108:111], v[80:83], v[12:15]
    ds_read_b64_tr_b16 v[124:125], v146 offset:10240
    v_mfma_f32_16x16x32_bf16 v[16:19], v[112:115], v[80:83], v[16:19]
    ds_read_b64_tr_b16 v[126:127], v146 offset:11520
    v_mfma_f32_16x16x32_bf16 v[0:3], v[96:99], v[80:83], v[0:3]
    ds_read_b128 v[80:83], v143 offset:0
    v_mfma_f32_16x16x32_bf16 v[24:27], v[100:103], v[84:87], v[24:27]
    ds_read_b64_tr_b16 v[128:129], v147 offset:10240
    v_mfma_f32_16x16x32_bf16 v[28:31], v[104:107], v[84:87], v[28:31]
    ds_read_b64_tr_b16 v[130:131], v147 offset:11520
    v_mfma_f32_16x16x32_bf16 v[32:35], v[108:111], v[84:87], v[32:35]
    ds_read_b64_tr_b16 v[132:133], v148 offset:10240
    v_mfma_f32_16x16x32_bf16 v[36:39], v[112:115], v[84:87], v[36:39]
    ds_read_b64_tr_b16 v[134:135], v148 offset:11520
    v_mfma_f32_16x16x32_bf16 v[20:23], v[96:99], v[84:87], v[20:23]
    ds_read_b128 v[84:87], v143 offset:2048
    s_waitcnt lgkmcnt(11)
    v_mfma_f32_16x16x32_bf16 v[44:47], v[100:103], v[88:91], v[44:47]
    ds_read_b64_tr_b16 v[116:117], v144 offset:10240
    v_mfma_f32_16x16x32_bf16 v[48:51], v[104:107], v[88:91], v[48:51]
    ds_read_b64_tr_b16 v[118:119], v144 offset:11520
    v_mfma_f32_16x16x32_bf16 v[52:55], v[108:111], v[88:91], v[52:55]
    s_add_u32 s40, s40, 1
    s_add_u32 s41, s40, 2
    v_mfma_f32_16x16x32_bf16 v[56:59], v[112:115], v[88:91], v[56:59]
    s_and_b32 s41, s41, 3
    s_mul_i32 s42, s41, 36864
    v_mfma_f32_16x16x32_bf16 v[40:43], v[96:99], v[88:91], v[40:43]
    ds_read_b128 v[88:91], v143 offset:4096
    s_waitcnt lgkmcnt(13)
    v_mfma_f32_16x16x32_bf16 v[64:67], v[100:103], v[92:95], v[64:67]
    v_add_u32 v142, s42, v136
    v_add_u32 v144, s42, v137
    v_mfma_f32_16x16x32_bf16 v[68:71], v[104:107], v[92:95], v[68:71]
    v_add_u32 v145, s42, v138
    v_add_u32 v146, s42, v139
    v_mfma_f32_16x16x32_bf16 v[72:75], v[108:111], v[92:95], v[72:75]
    v_add_u32 v147, s42, v140
    v_add_u32 v148, s42, v141
    v_mfma_f32_16x16x32_bf16 v[76:79], v[112:115], v[92:95], v[76:79]
    v_mfma_f32_16x16x32_bf16 v[60:63], v[96:99], v[92:95], v[60:63]
    ds_read_b128 v[92:95], v143 offset:6144
    s_cmp_lt_u32 s40, s43
    s_cbranch_scc1 P1_LOOP_QK
    s_cmp_lg_u32 s22, 0
    s_cbranch_scc1 P1_TAIL_K
    s_mov_b32 s39, 0x3ea52b5c
    v_xor_b32 v143, 64, v142
    s_waitcnt lgkmcnt(0)
    s_barrier
    v_mfma_f32_16x16x32_bf16 v[4:7], v[120:123], v[80:83], v[4:7]
    ds_read_b64_tr_b16 v[96:97], v145 offset:0
    v_mfma_f32_16x16x32_bf16 v[8:11], v[124:127], v[80:83], v[8:11]
    ds_read_b64_tr_b16 v[98:99], v145 offset:1280
    v_mfma_f32_16x16x32_bf16 v[12:15], v[128:131], v[80:83], v[12:15]
    ds_read_b128 v[100:103], v142 offset:0
    v_mfma_f32_16x16x32_bf16 v[16:19], v[132:135], v[80:83], v[16:19]
    ds_read_b64_tr_b16 v[104:105], v146 offset:0
    v_mfma_f32_16x16x32_bf16 v[0:3], v[116:119], v[80:83], v[0:3]
    ds_read_b64_tr_b16 v[106:107], v146 offset:1280
    v_mfma_f32_16x16x32_bf16 v[24:27], v[120:123], v[84:87], v[24:27]
    ds_read_b64_tr_b16 v[108:109], v147 offset:0
    v_mfma_f32_16x16x32_bf16 v[28:31], v[124:127], v[84:87], v[28:31]
    ds_read_b64_tr_b16 v[110:111], v147 offset:1280
    v_mfma_f32_16x16x32_bf16 v[32:35], v[128:131], v[84:87], v[32:35]
    ds_read_b64_tr_b16 v[112:113], v148 offset:0
    v_mfma_f32_16x16x32_bf16 v[36:39], v[132:135], v[84:87], v[36:39]
    ds_read_b64_tr_b16 v[114:115], v148 offset:1280
    v_mfma_f32_16x16x32_bf16 v[20:23], v[116:119], v[84:87], v[20:23]
    ds_read_b64_tr_b16 v[136:137], v144 offset:0
    v_mfma_f32_16x16x32_bf16 v[44:47], v[120:123], v[88:91], v[44:47]
    ds_read_b64_tr_b16 v[138:139], v144 offset:1280
    v_mfma_f32_16x16x32_bf16 v[48:51], v[124:127], v[88:91], v[48:51]
    ds_read_b128 v[80:83], v142 offset:2048
    v_mfma_f32_16x16x32_bf16 v[52:55], v[128:131], v[88:91], v[52:55]
    ds_read_b128 v[84:87], v142 offset:4096
    v_mfma_f32_16x16x32_bf16 v[56:59], v[132:135], v[88:91], v[56:59]
    v_mfma_f32_16x16x32_bf16 v[40:43], v[116:119], v[88:91], v[40:43]
    ds_read_b128 v[88:91], v142 offset:6144
    v_mfma_f32_16x16x32_bf16 v[64:67], v[120:123], v[92:95], v[64:67]
    ds_read_b64_tr_b16 v[120:121], v145 offset:10240
    v_mfma_f32_16x16x32_bf16 v[68:71], v[124:127], v[92:95], v[68:71]
    ds_read_b64_tr_b16 v[122:123], v145 offset:11520
    v_mfma_f32_16x16x32_bf16 v[72:75], v[128:131], v[92:95], v[72:75]
    ds_read_b128 v[124:127], v143 offset:0
    v_mfma_f32_16x16x32_bf16 v[76:79], v[132:135], v[92:95], v[76:79]
    ds_read_b64_tr_b16 v[128:129], v146 offset:10240
    v_mfma_f32_16x16x32_bf16 v[60:63], v[116:119], v[92:95], v[60:63]
    ds_read_b64_tr_b16 v[130:131], v146 offset:11520
    s_waitcnt lgkmcnt(6)
    v_mfma_f32_16x16x32_bf16 v[4:7], v[96:99], v[100:103], v[4:7]
    ds_read_b64_tr_b16 v[132:133], v147 offset:10240
    v_mfma_f32_16x16x32_bf16 v[8:11], v[104:107], v[100:103], v[8:11]
    ds_read_b64_tr_b16 v[134:135], v147 offset:11520
    v_mfma_f32_16x16x32_bf16 v[12:15], v[108:111], v[100:103], v[12:15]
    ds_read_b64_tr_b16 v[92:93], v148 offset:10240
    v_mfma_f32_16x16x32_bf16 v[16:19], v[112:115], v[100:103], v[16:19]
    ds_read_b64_tr_b16 v[94:95], v148 offset:11520
    v_mfma_f32_16x16x32_bf16 v[0:3], v[136:139], v[100:103], v[0:3]
    ds_read_b64_tr_b16 v[116:117], v144 offset:10240
    v_mfma_f32_16x16x32_bf16 v[24:27], v[96:99], v[80:83], v[24:27]
    ds_read_b64_tr_b16 v[118:119], v144 offset:11520
    v_mfma_f32_16x16x32_bf16 v[28:31], v[104:107], v[80:83], v[28:31]
    ds_read_b128 v[100:103], v143 offset:2048
    v_mfma_f32_16x16x32_bf16 v[32:35], v[108:111], v[80:83], v[32:35]
    v_mfma_f32_16x16x32_bf16 v[36:39], v[112:115], v[80:83], v[36:39]
    v_mfma_f32_16x16x32_bf16 v[20:23], v[136:139], v[80:83], v[20:23]
    ds_read_b128 v[80:83], v143 offset:4096
    v_mfma_f32_16x16x32_bf16 v[44:47], v[96:99], v[84:87], v[44:47]
    v_mfma_f32_16x16x32_bf16 v[48:51], v[104:107], v[84:87], v[48:51]
    v_mfma_f32_16x16x32_bf16 v[52:55], v[108:111], v[84:87], v[52:55]
    v_mfma_f32_16x16x32_bf16 v[56:59], v[112:115], v[84:87], v[56:59]
    v_mfma_f32_16x16x32_bf16 v[40:43], v[136:139], v[84:87], v[40:43]
    ds_read_b128 v[84:87], v143 offset:6144
    s_waitcnt lgkmcnt(6)
    v_mfma_f32_16x16x32_bf16 v[64:67], v[96:99], v[88:91], v[64:67]
    s_barrier
    ds_read_b64_tr_b16 v[96:97], v144 offset:36864
    v_mfma_f32_16x16x32_bf16 v[68:71], v[104:107], v[88:91], v[68:71]
    ds_read_b64_tr_b16 v[98:99], v144 offset:38144
    v_mfma_f32_16x16x32_bf16 v[72:75], v[108:111], v[88:91], v[72:75]
    ds_read_b128 v[104:107], v142 offset:36864
    v_mfma_f32_16x16x32_bf16 v[76:79], v[112:115], v[88:91], v[76:79]
    ds_read_b128 v[108:111], v142 offset:38912
    v_mfma_f32_16x16x32_bf16 v[60:63], v[136:139], v[88:91], v[60:63]
    ds_read_b64_tr_b16 v[112:113], v144 offset:47104
    v_mfma_f32_16x16x32_bf16 v[4:7], v[120:123], v[124:127], v[4:7]
    ds_read_b64_tr_b16 v[114:115], v144 offset:48384
    v_mfma_f32_16x16x32_bf16 v[8:11], v[128:131], v[124:127], v[8:11]
    ds_read_b128 v[88:91], v143 offset:36864
    v_mfma_f32_16x16x32_bf16 v[12:15], v[132:135], v[124:127], v[12:15]
    ds_read_b128 v[136:139], v143 offset:38912
    s_waitcnt lgkmcnt(6)
    v_mfma_f32_16x16x32_bf16 v[16:19], v[92:95], v[124:127], v[16:19]
    v_mfma_f32_16x16x32_bf16 v[0:3], v[116:119], v[124:127], v[0:3]
    ds_read_b128 v[124:127], v142 offset:40960
    v_mfma_f32_16x16x32_bf16 v[24:27], v[120:123], v[100:103], v[24:27]
    v_mfma_f32_16x16x32_bf16 v[28:31], v[128:131], v[100:103], v[28:31]
    v_mfma_f32_16x16x32_bf16 v[32:35], v[132:135], v[100:103], v[32:35]
    v_mfma_f32_16x16x32_bf16 v[36:39], v[92:95], v[100:103], v[36:39]
    v_mfma_f32_16x16x32_bf16 v[20:23], v[116:119], v[100:103], v[20:23]
    ds_read_b128 v[100:103], v142 offset:43008
    v_mfma_f32_16x16x32_bf16 v[44:47], v[120:123], v[80:83], v[44:47]
    v_mfma_f32_16x16x32_bf16 v[48:51], v[128:131], v[80:83], v[48:51]
    v_mfma_f32_16x16x32_bf16 v[52:55], v[132:135], v[80:83], v[52:55]
    v_mfma_f32_16x16x32_bf16 v[56:59], v[92:95], v[80:83], v[56:59]
    v_mfma_f32_16x16x32_bf16 v[40:43], v[116:119], v[80:83], v[40:43]
    ds_read_b128 v[80:83], v143 offset:40960
    v_mfma_f32_16x16x32_bf16 v[64:67], v[120:123], v[84:87], v[64:67]
    ds_read_b128 v[120:123], v143 offset:43008
    v_mfma_f32_16x16x32_bf16 v[68:71], v[128:131], v[84:87], v[68:71]
    ds_read_b64_tr_b16 v[128:129], v145 offset:36864
    v_mfma_f32_16x16x32_bf16 v[72:75], v[132:135], v[84:87], v[72:75]
    ds_read_b64_tr_b16 v[130:131], v145 offset:38144
    v_mfma_f32_16x16x32_bf16 v[76:79], v[92:95], v[84:87], v[76:79]
    ds_read_b64_tr_b16 v[132:133], v145 offset:47104
    v_mfma_f32_16x16x32_bf16 v[60:63], v[116:119], v[84:87], v[60:63]
    ds_read_b64_tr_b16 v[134:135], v145 offset:48384
    s_waitcnt lgkmcnt(6)
    v_mfma_f32_16x16x32_bf16 v[0:3], v[96:99], v[104:107], v[0:3]
    ds_read_b64_tr_b16 v[92:93], v146 offset:36864
    v_mfma_f32_16x16x32_bf16 v[20:23], v[96:99], v[108:111], v[20:23]
    ds_read_b64_tr_b16 v[94:95], v146 offset:38144
    v_mfma_f32_16x16x32_bf16 v[0:3], v[112:115], v[88:91], v[0:3]
    ds_read_b64_tr_b16 v[84:85], v146 offset:47104
    v_mfma_f32_16x16x32_bf16 v[20:23], v[112:115], v[136:139], v[20:23]
    ds_read_b64_tr_b16 v[86:87], v146 offset:48384
    v_mfma_f32_16x16x32_bf16 v[40:43], v[96:99], v[124:127], v[40:43]
    ds_read_b64_tr_b16 v[116:117], v147 offset:36864
    v_mfma_f32_16x16x32_bf16 v[60:63], v[96:99], v[100:103], v[60:63]
    ds_read_b64_tr_b16 v[118:119], v147 offset:38144
    s_waitcnt lgkmcnt(6)
    v_mfma_f32_16x16x32_bf16 v[40:43], v[112:115], v[80:83], v[40:43]
    ds_read_b64_tr_b16 v[96:97], v147 offset:47104
    v_mul_f32 v0, s39, v0
    v_mul_f32 v1, s39, v1
    v_mul_f32 v2, s39, v2
    v_mul_f32 v3, s39, v3
    v_mfma_f32_16x16x32_bf16 v[60:63], v[112:115], v[120:123], v[60:63]
    ds_read_b64_tr_b16 v[98:99], v147 offset:48384
    v_mul_f32 v20, s39, v20
    v_mul_f32 v21, s39, v21
    v_mul_f32 v22, s39, v22
    v_mul_f32 v23, s39, v23
    v_mfma_f32_16x16x32_bf16 v[4:7], v[128:131], v[104:107], v[4:7]
    ds_read_b64_tr_b16 v[112:113], v148 offset:36864
    v_cvt_pk_bf16_f32 v0, v0, v1
    v_cvt_pk_bf16_f32 v1, v2, v3
    v_cvt_pk_bf16_f32 v2, v20, v21
    v_cvt_pk_bf16_f32 v3, v22, v23
    v_mfma_f32_16x16x32_bf16 v[24:27], v[128:131], v[108:111], v[24:27]
    ds_read_b64_tr_b16 v[114:115], v148 offset:38144
    v_permlane16_swap_b32 v0, v2
    v_permlane16_swap_b32 v1, v3
    buffer_store_dwordx4 v[0:3], v151, s[28:31], s26 offen sc1
    v_mul_f32 v40, s39, v40
    v_mfma_f32_16x16x32_bf16 v[4:7], v[132:135], v[88:91], v[4:7]
    v_mul_f32 v41, s39, v41
    v_mul_f32 v42, s39, v42
    v_mul_f32 v43, s39, v43
    v_mul_f32 v60, s39, v60
    v_mfma_f32_16x16x32_bf16 v[24:27], v[132:135], v[136:139], v[24:27]
    v_mul_f32 v61, s39, v61
    v_mul_f32 v62, s39, v62
    v_mul_f32 v63, s39, v63
    v_cvt_pk_bf16_f32 v40, v40, v41
    v_mfma_f32_16x16x32_bf16 v[44:47], v[128:131], v[124:127], v[44:47]
    v_cvt_pk_bf16_f32 v41, v42, v43
    v_cvt_pk_bf16_f32 v42, v60, v61
    v_cvt_pk_bf16_f32 v43, v62, v63
    v_mfma_f32_16x16x32_bf16 v[64:67], v[128:131], v[100:103], v[64:67]
    ds_read_b64_tr_b16 v[128:129], v148 offset:47104
    v_permlane16_swap_b32 v40, v42
    v_permlane16_swap_b32 v41, v43
    buffer_store_dwordx4 v[40:43], v151, s[28:31], s27 offen sc1
    v_mul_f32 v4, s39, v4
    v_mfma_f32_16x16x32_bf16 v[44:47], v[132:135], v[80:83], v[44:47]
    ds_read_b64_tr_b16 v[130:131], v148 offset:48384
    v_mul_f32 v5, s39, v5
    v_mul_f32 v6, s39, v6
    v_mul_f32 v7, s39, v7
    v_mul_f32 v24, s39, v24
    v_mfma_f32_16x16x32_bf16 v[64:67], v[132:135], v[120:123], v[64:67]
    v_mul_f32 v25, s39, v25
    v_mul_f32 v26, s39, v26
    v_mul_f32 v27, s39, v27
    v_cvt_pk_bf16_f32 v4, v4, v5
    s_waitcnt lgkmcnt(6)
    v_mfma_f32_16x16x32_bf16 v[8:11], v[92:95], v[104:107], v[8:11]
    v_cvt_pk_bf16_f32 v5, v6, v7
    v_cvt_pk_bf16_f32 v6, v24, v25
    v_cvt_pk_bf16_f32 v7, v26, v27
    v_mfma_f32_16x16x32_bf16 v[28:31], v[92:95], v[108:111], v[28:31]
    v_permlane16_swap_b32 v4, v6
    v_permlane16_swap_b32 v5, v7
    buffer_store_dwordx4 v[4:7], v151, s[28:31], s44 offen sc1
    v_mul_f32 v44, s39, v44
    v_mfma_f32_16x16x32_bf16 v[8:11], v[84:87], v[88:91], v[8:11]
    v_mul_f32 v45, s39, v45
    v_mul_f32 v46, s39, v46
    v_mul_f32 v47, s39, v47
    v_mul_f32 v64, s39, v64
    v_mfma_f32_16x16x32_bf16 v[28:31], v[84:87], v[136:139], v[28:31]
    v_mul_f32 v65, s39, v65
    v_mul_f32 v66, s39, v66
    v_mul_f32 v67, s39, v67
    v_cvt_pk_bf16_f32 v44, v44, v45
    v_mfma_f32_16x16x32_bf16 v[48:51], v[92:95], v[124:127], v[48:51]
    v_cvt_pk_bf16_f32 v45, v46, v47
    v_cvt_pk_bf16_f32 v46, v64, v65
    v_cvt_pk_bf16_f32 v47, v66, v67
    v_mfma_f32_16x16x32_bf16 v[68:71], v[92:95], v[100:103], v[68:71]
    v_permlane16_swap_b32 v44, v46
    v_permlane16_swap_b32 v45, v47
    buffer_store_dwordx4 v[44:47], v151, s[28:31], s45 offen sc1
    v_mul_f32 v8, s39, v8
    v_mfma_f32_16x16x32_bf16 v[48:51], v[84:87], v[80:83], v[48:51]
    v_mul_f32 v9, s39, v9
    v_mul_f32 v10, s39, v10
    v_mul_f32 v11, s39, v11
    v_mul_f32 v28, s39, v28
    v_mfma_f32_16x16x32_bf16 v[68:71], v[84:87], v[120:123], v[68:71]
    v_mul_f32 v29, s39, v29
    v_mul_f32 v30, s39, v30
    v_mul_f32 v31, s39, v31
    v_cvt_pk_bf16_f32 v8, v8, v9
    v_mfma_f32_16x16x32_bf16 v[12:15], v[116:119], v[104:107], v[12:15]
    v_cvt_pk_bf16_f32 v9, v10, v11
    v_cvt_pk_bf16_f32 v10, v28, v29
    v_cvt_pk_bf16_f32 v11, v30, v31
    v_mfma_f32_16x16x32_bf16 v[32:35], v[116:119], v[108:111], v[32:35]
    v_permlane16_swap_b32 v8, v10
    v_permlane16_swap_b32 v9, v11
    buffer_store_dwordx4 v[8:11], v151, s[28:31], s46 offen sc1
    v_mul_f32 v48, s39, v48
    s_waitcnt lgkmcnt(4)
    v_mfma_f32_16x16x32_bf16 v[12:15], v[96:99], v[88:91], v[12:15]
    v_mul_f32 v49, s39, v49
    v_mul_f32 v50, s39, v50
    v_mul_f32 v51, s39, v51
    v_mul_f32 v68, s39, v68
    v_mfma_f32_16x16x32_bf16 v[32:35], v[96:99], v[136:139], v[32:35]
    v_mul_f32 v69, s39, v69
    v_mul_f32 v70, s39, v70
    v_mul_f32 v71, s39, v71
    v_cvt_pk_bf16_f32 v48, v48, v49
    v_mfma_f32_16x16x32_bf16 v[52:55], v[116:119], v[124:127], v[52:55]
    v_cvt_pk_bf16_f32 v49, v50, v51
    v_cvt_pk_bf16_f32 v50, v68, v69
    v_cvt_pk_bf16_f32 v51, v70, v71
    v_mfma_f32_16x16x32_bf16 v[72:75], v[116:119], v[100:103], v[72:75]
    v_permlane16_swap_b32 v48, v50
    v_permlane16_swap_b32 v49, v51
    buffer_store_dwordx4 v[48:51], v151, s[28:31], s47 offen sc1
    v_mul_f32 v12, s39, v12
    v_mfma_f32_16x16x32_bf16 v[52:55], v[96:99], v[80:83], v[52:55]
    v_mul_f32 v13, s39, v13
    v_mul_f32 v14, s39, v14
    v_mul_f32 v15, s39, v15
    v_mul_f32 v32, s39, v32
    v_mfma_f32_16x16x32_bf16 v[72:75], v[96:99], v[120:123], v[72:75]
    v_mul_f32 v33, s39, v33
    v_mul_f32 v34, s39, v34
    v_mul_f32 v35, s39, v35
    v_cvt_pk_bf16_f32 v12, v12, v13
    s_waitcnt lgkmcnt(2)
    v_mfma_f32_16x16x32_bf16 v[16:19], v[112:115], v[104:107], v[16:19]
    v_cvt_pk_bf16_f32 v13, v14, v15
    v_cvt_pk_bf16_f32 v14, v32, v33
    v_cvt_pk_bf16_f32 v15, v34, v35
    v_mfma_f32_16x16x32_bf16 v[36:39], v[112:115], v[108:111], v[36:39]
    v_permlane16_swap_b32 v12, v14
    v_permlane16_swap_b32 v13, v15
    buffer_store_dwordx4 v[12:15], v151, s[28:31], s32 offen sc1
    v_mul_f32 v52, s39, v52
    s_waitcnt lgkmcnt(0)
    v_mfma_f32_16x16x32_bf16 v[16:19], v[128:131], v[88:91], v[16:19]
    v_mul_f32 v53, s39, v53
    v_mul_f32 v54, s39, v54
    v_mul_f32 v55, s39, v55
    v_mul_f32 v72, s39, v72
    v_mfma_f32_16x16x32_bf16 v[36:39], v[128:131], v[136:139], v[36:39]
    v_mul_f32 v73, s39, v73
    v_mul_f32 v74, s39, v74
    v_mul_f32 v75, s39, v75
    v_cvt_pk_bf16_f32 v52, v52, v53
    v_mfma_f32_16x16x32_bf16 v[56:59], v[112:115], v[124:127], v[56:59]
    v_cvt_pk_bf16_f32 v53, v54, v55
    v_cvt_pk_bf16_f32 v54, v72, v73
    v_cvt_pk_bf16_f32 v55, v74, v75
    v_mfma_f32_16x16x32_bf16 v[76:79], v[112:115], v[100:103], v[76:79]
    v_permlane16_swap_b32 v52, v54
    v_permlane16_swap_b32 v53, v55
    buffer_store_dwordx4 v[52:55], v151, s[28:31], s33 offen sc1
    v_mul_f32 v16, s39, v16
    v_mfma_f32_16x16x32_bf16 v[56:59], v[128:131], v[80:83], v[56:59]
    v_mul_f32 v17, s39, v17
    v_mul_f32 v18, s39, v18
    v_mul_f32 v19, s39, v19
    v_mul_f32 v36, s39, v36
    v_mfma_f32_16x16x32_bf16 v[76:79], v[128:131], v[120:123], v[76:79]
    v_mul_f32 v37, s39, v37
    v_mul_f32 v38, s39, v38
    v_mul_f32 v39, s39, v39
    v_cvt_pk_bf16_f32 v16, v16, v17
    v_cvt_pk_bf16_f32 v17, v18, v19
    v_cvt_pk_bf16_f32 v18, v36, v37
    v_cvt_pk_bf16_f32 v19, v38, v39
    buffer_store_dwordx4 v[16:19], v167, s[28:31], s26 offen offset:1024 sc1
    v_mul_f32 v56, s39, v56
    v_mul_f32 v57, s39, v57
    v_mul_f32 v58, s39, v58
    v_mul_f32 v59, s39, v59
    v_mul_f32 v76, s39, v76
    v_mul_f32 v77, s39, v77
    v_mul_f32 v78, s39, v78
    v_mul_f32 v79, s39, v79
    v_cvt_pk_bf16_f32 v56, v56, v57
    v_cvt_pk_bf16_f32 v57, v58, v59
    v_cvt_pk_bf16_f32 v58, v76, v77
    v_cvt_pk_bf16_f32 v59, v78, v79
    buffer_store_dwordx4 v[56:59], v167, s[28:31], s27 offen offset:1024 sc1
    s_branch P1_DONE
P1_TAIL_K:
    s_cmp_eq_u32 s12, 1
    s_cselect_b32 s30, 0, s30
    v_xor_b32 v143, 64, v142
    s_waitcnt lgkmcnt(0)
    s_barrier
    v_mfma_f32_16x16x32_bf16 v[4:7], v[120:123], v[80:83], v[4:7]
    ds_read_b64_tr_b16 v[96:97], v145 offset:0
    v_mfma_f32_16x16x32_bf16 v[8:11], v[124:127], v[80:83], v[8:11]
    ds_read_b64_tr_b16 v[98:99], v145 offset:1280
    v_mfma_f32_16x16x32_bf16 v[12:15], v[128:131], v[80:83], v[12:15]
    ds_read_b128 v[100:103], v142 offset:0
    v_mfma_f32_16x16x32_bf16 v[16:19], v[132:135], v[80:83], v[16:19]
    ds_read_b64_tr_b16 v[104:105], v146 offset:0
    v_mfma_f32_16x16x32_bf16 v[0:3], v[116:119], v[80:83], v[0:3]
    ds_read_b64_tr_b16 v[106:107], v146 offset:1280
    v_mfma_f32_16x16x32_bf16 v[24:27], v[120:123], v[84:87], v[24:27]
    ds_read_b64_tr_b16 v[108:109], v147 offset:0
    v_mfma_f32_16x16x32_bf16 v[28:31], v[124:127], v[84:87], v[28:31]
    ds_read_b64_tr_b16 v[110:111], v147 offset:1280
    v_mfma_f32_16x16x32_bf16 v[32:35], v[128:131], v[84:87], v[32:35]
    ds_read_b64_tr_b16 v[112:113], v148 offset:0
    v_mfma_f32_16x16x32_bf16 v[36:39], v[132:135], v[84:87], v[36:39]
    ds_read_b64_tr_b16 v[114:115], v148 offset:1280
    v_mfma_f32_16x16x32_bf16 v[20:23], v[116:119], v[84:87], v[20:23]
    ds_read_b64_tr_b16 v[136:137], v144 offset:0
    v_mfma_f32_16x16x32_bf16 v[44:47], v[120:123], v[88:91], v[44:47]
    ds_read_b64_tr_b16 v[138:139], v144 offset:1280
    v_mfma_f32_16x16x32_bf16 v[48:51], v[124:127], v[88:91], v[48:51]
    ds_read_b128 v[80:83], v142 offset:2048
    v_mfma_f32_16x16x32_bf16 v[52:55], v[128:131], v[88:91], v[52:55]
    ds_read_b128 v[84:87], v142 offset:4096
    v_mfma_f32_16x16x32_bf16 v[56:59], v[132:135], v[88:91], v[56:59]
    v_mfma_f32_16x16x32_bf16 v[40:43], v[116:119], v[88:91], v[40:43]
    ds_read_b128 v[88:91], v142 offset:6144
    v_mfma_f32_16x16x32_bf16 v[64:67], v[120:123], v[92:95], v[64:67]
    ds_read_b64_tr_b16 v[120:121], v145 offset:10240
    v_mfma_f32_16x16x32_bf16 v[68:71], v[124:127], v[92:95], v[68:71]
    ds_read_b64_tr_b16 v[122:123], v145 offset:11520
    v_mfma_f32_16x16x32_bf16 v[72:75], v[128:131], v[92:95], v[72:75]
    ds_read_b128 v[124:127], v143 offset:0
    v_mfma_f32_16x16x32_bf16 v[76:79], v[132:135], v[92:95], v[76:79]
    ds_read_b64_tr_b16 v[128:129], v146 offset:10240
    v_mfma_f32_16x16x32_bf16 v[60:63], v[116:119], v[92:95], v[60:63]
    ds_read_b64_tr_b16 v[130:131], v146 offset:11520
    s_waitcnt lgkmcnt(6)
    v_mfma_f32_16x16x32_bf16 v[4:7], v[96:99], v[100:103], v[4:7]
    ds_read_b64_tr_b16 v[132:133], v147 offset:10240
    v_mfma_f32_16x16x32_bf16 v[8:11], v[104:107], v[100:103], v[8:11]
    ds_read_b64_tr_b16 v[134:135], v147 offset:11520
    v_mfma_f32_16x16x32_bf16 v[12:15], v[108:111], v[100:103], v[12:15]
    ds_read_b64_tr_b16 v[92:93], v148 offset:10240
    v_mfma_f32_16x16x32_bf16 v[16:19], v[112:115], v[100:103], v[16:19]
    ds_read_b64_tr_b16 v[94:95], v148 offset:11520
    v_mfma_f32_16x16x32_bf16 v[0:3], v[136:139], v[100:103], v[0:3]
    ds_read_b64_tr_b16 v[116:117], v144 offset:10240
    v_mfma_f32_16x16x32_bf16 v[24:27], v[96:99], v[80:83], v[24:27]
    ds_read_b64_tr_b16 v[118:119], v144 offset:11520
    v_mfma_f32_16x16x32_bf16 v[28:31], v[104:107], v[80:83], v[28:31]
    ds_read_b128 v[100:103], v143 offset:2048
    v_mfma_f32_16x16x32_bf16 v[32:35], v[108:111], v[80:83], v[32:35]
    v_mfma_f32_16x16x32_bf16 v[36:39], v[112:115], v[80:83], v[36:39]
    v_mfma_f32_16x16x32_bf16 v[20:23], v[136:139], v[80:83], v[20:23]
    ds_read_b128 v[80:83], v143 offset:4096
    v_mfma_f32_16x16x32_bf16 v[44:47], v[96:99], v[84:87], v[44:47]
    v_mfma_f32_16x16x32_bf16 v[48:51], v[104:107], v[84:87], v[48:51]
    v_mfma_f32_16x16x32_bf16 v[52:55], v[108:111], v[84:87], v[52:55]
    v_mfma_f32_16x16x32_bf16 v[56:59], v[112:115], v[84:87], v[56:59]
    v_mfma_f32_16x16x32_bf16 v[40:43], v[136:139], v[84:87], v[40:43]
    ds_read_b128 v[84:87], v143 offset:6144
    s_waitcnt lgkmcnt(6)
    v_mfma_f32_16x16x32_bf16 v[64:67], v[96:99], v[88:91], v[64:67]
    s_barrier
    ds_read_b64_tr_b16 v[96:97], v144 offset:36864
    v_mfma_f32_16x16x32_bf16 v[68:71], v[104:107], v[88:91], v[68:71]
    ds_read_b64_tr_b16 v[98:99], v144 offset:38144
    v_mfma_f32_16x16x32_bf16 v[72:75], v[108:111], v[88:91], v[72:75]
    ds_read_b128 v[104:107], v142 offset:36864
    v_mfma_f32_16x16x32_bf16 v[76:79], v[112:115], v[88:91], v[76:79]
    ds_read_b128 v[108:111], v142 offset:38912
    v_mfma_f32_16x16x32_bf16 v[60:63], v[136:139], v[88:91], v[60:63]
    ds_read_b64_tr_b16 v[112:113], v144 offset:47104
    v_mfma_f32_16x16x32_bf16 v[4:7], v[120:123], v[124:127], v[4:7]
    ds_read_b64_tr_b16 v[114:115], v144 offset:48384
    v_mfma_f32_16x16x32_bf16 v[8:11], v[128:131], v[124:127], v[8:11]
    ds_read_b128 v[88:91], v143 offset:36864
    v_mfma_f32_16x16x32_bf16 v[12:15], v[132:135], v[124:127], v[12:15]
    ds_read_b128 v[136:139], v143 offset:38912
    s_waitcnt lgkmcnt(6)
    v_mfma_f32_16x16x32_bf16 v[16:19], v[92:95], v[124:127], v[16:19]
    v_mfma_f32_16x16x32_bf16 v[0:3], v[116:119], v[124:127], v[0:3]
    ds_read_b128 v[124:127], v142 offset:40960
    v_mfma_f32_16x16x32_bf16 v[24:27], v[120:123], v[100:103], v[24:27]
    v_mfma_f32_16x16x32_bf16 v[28:31], v[128:131], v[100:103], v[28:31]
    v_mfma_f32_16x16x32_bf16 v[32:35], v[132:135], v[100:103], v[32:35]
    v_mfma_f32_16x16x32_bf16 v[36:39], v[92:95], v[100:103], v[36:39]
    v_mfma_f32_16x16x32_bf16 v[20:23], v[116:119], v[100:103], v[20:23]
    ds_read_b128 v[100:103], v142 offset:43008
    v_mfma_f32_16x16x32_bf16 v[44:47], v[120:123], v[80:83], v[44:47]
    v_mfma_f32_16x16x32_bf16 v[48:51], v[128:131], v[80:83], v[48:51]
    v_mfma_f32_16x16x32_bf16 v[52:55], v[132:135], v[80:83], v[52:55]
    v_mfma_f32_16x16x32_bf16 v[56:59], v[92:95], v[80:83], v[56:59]
    v_mfma_f32_16x16x32_bf16 v[40:43], v[116:119], v[80:83], v[40:43]
    ds_read_b128 v[80:83], v143 offset:40960
    v_mfma_f32_16x16x32_bf16 v[64:67], v[120:123], v[84:87], v[64:67]
    ds_read_b128 v[120:123], v143 offset:43008
    v_mfma_f32_16x16x32_bf16 v[68:71], v[128:131], v[84:87], v[68:71]
    ds_read_b64_tr_b16 v[128:129], v145 offset:36864
    v_mfma_f32_16x16x32_bf16 v[72:75], v[132:135], v[84:87], v[72:75]
    ds_read_b64_tr_b16 v[130:131], v145 offset:38144
    v_mfma_f32_16x16x32_bf16 v[76:79], v[92:95], v[84:87], v[76:79]
    ds_read_b64_tr_b16 v[132:133], v145 offset:47104
    v_mfma_f32_16x16x32_bf16 v[60:63], v[116:119], v[84:87], v[60:63]
    ds_read_b64_tr_b16 v[134:135], v145 offset:48384
    s_waitcnt lgkmcnt(6)
    v_mfma_f32_16x16x32_bf16 v[0:3], v[96:99], v[104:107], v[0:3]
    ds_read_b64_tr_b16 v[92:93], v146 offset:36864
    v_mfma_f32_16x16x32_bf16 v[20:23], v[96:99], v[108:111], v[20:23]
    ds_read_b64_tr_b16 v[94:95], v146 offset:38144
    v_mfma_f32_16x16x32_bf16 v[0:3], v[112:115], v[88:91], v[0:3]
    ds_read_b64_tr_b16 v[84:85], v146 offset:47104
    v_mfma_f32_16x16x32_bf16 v[20:23], v[112:115], v[136:139], v[20:23]
    ds_read_b64_tr_b16 v[86:87], v146 offset:48384
    v_mfma_f32_16x16x32_bf16 v[40:43], v[96:99], v[124:127], v[40:43]
    ds_read_b64_tr_b16 v[116:117], v147 offset:36864
    v_mfma_f32_16x16x32_bf16 v[60:63], v[96:99], v[100:103], v[60:63]
    ds_read_b64_tr_b16 v[118:119], v147 offset:38144
    s_waitcnt lgkmcnt(6)
    v_mfma_f32_16x16x32_bf16 v[40:43], v[112:115], v[80:83], v[40:43]
    ds_read_b64_tr_b16 v[96:97], v147 offset:47104
    v_cvt_pk_bf16_f32 v0, v0, v1
    v_cvt_pk_bf16_f32 v1, v2, v3
    v_mfma_f32_16x16x32_bf16 v[60:63], v[112:115], v[120:123], v[60:63]
    ds_read_b64_tr_b16 v[98:99], v147 offset:48384
    v_cvt_pk_bf16_f32 v2, v20, v21
    v_cvt_pk_bf16_f32 v3, v22, v23
    v_mfma_f32_16x16x32_bf16 v[4:7], v[128:131], v[104:107], v[4:7]
    ds_read_b64_tr_b16 v[112:113], v148 offset:36864
    v_permlane16_swap_b32 v0, v2
    v_permlane16_swap_b32 v1, v3
    v_mfma_f32_16x16x32_bf16 v[24:27], v[128:131], v[108:111], v[24:27]
    ds_read_b64_tr_b16 v[114:115], v148 offset:38144
    buffer_store_dwordx4 v[0:3], v151, s[28:31], s26 offen sc1
    v_cvt_pk_bf16_f32 v40, v40, v41
    v_mfma_f32_16x16x32_bf16 v[4:7], v[132:135], v[88:91], v[4:7]
    v_cvt_pk_bf16_f32 v41, v42, v43
    v_cvt_pk_bf16_f32 v42, v60, v61
    v_mfma_f32_16x16x32_bf16 v[24:27], v[132:135], v[136:139], v[24:27]
    v_cvt_pk_bf16_f32 v43, v62, v63
    v_mfma_f32_16x16x32_bf16 v[44:47], v[128:131], v[124:127], v[44:47]
    v_permlane16_swap_b32 v40, v42
    v_permlane16_swap_b32 v41, v43
    v_mfma_f32_16x16x32_bf16 v[64:67], v[128:131], v[100:103], v[64:67]
    ds_read_b64_tr_b16 v[128:129], v148 offset:47104
    buffer_store_dwordx4 v[40:43], v151, s[28:31], s27 offen sc1
    v_mfma_f32_16x16x32_bf16 v[44:47], v[132:135], v[80:83], v[44:47]
    ds_read_b64_tr_b16 v[130:131], v148 offset:48384
    v_cvt_pk_bf16_f32 v4, v4, v5
    v_cvt_pk_bf16_f32 v5, v6, v7
    v_mfma_f32_16x16x32_bf16 v[64:67], v[132:135], v[120:123], v[64:67]
    v_cvt_pk_bf16_f32 v6, v24, v25
    v_cvt_pk_bf16_f32 v7, v26, v27
    s_waitcnt lgkmcnt(6)
    v_mfma_f32_16x16x32_bf16 v[8:11], v[92:95], v[104:107], v[8:11]
    v_permlane16_swap_b32 v4, v6
    v_permlane16_swap_b32 v5, v7
    v_mfma_f32_16x16x32_bf16 v[28:31], v[92:95], v[108:111], v[28:31]
    buffer_store_dwordx4 v[4:7], v151, s[28:31], s44 offen sc1
    v_cvt_pk_bf16_f32 v44, v44, v45
    v_mfma_f32_16x16x32_bf16 v[8:11], v[84:87], v[88:91], v[8:11]
    v_cvt_pk_bf16_f32 v45, v46, v47
    v_cvt_pk_bf16_f32 v46, v64, v65
    v_mfma_f32_16x16x32_bf16 v[28:31], v[84:87], v[136:139], v[28:31]
    v_cvt_pk_bf16_f32 v47, v66, v67
    v_mfma_f32_16x16x32_bf16 v[48:51], v[92:95], v[124:127], v[48:51]
    v_permlane16_swap_b32 v44, v46
    v_permlane16_swap_b32 v45, v47
    v_mfma_f32_16x16x32_bf16 v[68:71], v[92:95], v[100:103], v[68:71]
    buffer_store_dwordx4 v[44:47], v151, s[28:31], s45 offen sc1
    v_mfma_f32_16x16x32_bf16 v[48:51], v[84:87], v[80:83], v[48:51]
    v_mfma_f32_16x16x32_bf16 v[68:71], v[84:87], v[120:123], v[68:71]
    v_cvt_pk_bf16_f32 v8, v8, v9
    v_cvt_pk_bf16_f32 v9, v10, v11
    v_mfma_f32_16x16x32_bf16 v[12:15], v[116:119], v[104:107], v[12:15]
    v_cvt_pk_bf16_f32 v10, v28, v29
    v_cvt_pk_bf16_f32 v11, v30, v31
    v_mfma_f32_16x16x32_bf16 v[32:35], v[116:119], v[108:111], v[32:35]
    v_permlane16_swap_b32 v8, v10
    v_permlane16_swap_b32 v9, v11
    s_waitcnt lgkmcnt(4)
    v_mfma_f32_16x16x32_bf16 v[12:15], v[96:99], v[88:91], v[12:15]
    buffer_store_dwordx4 v[8:11], v151, s[28:31], s46 offen sc1
    v_cvt_pk_bf16_f32 v48, v48, v49
    v_mfma_f32_16x16x32_bf16 v[32:35], v[96:99], v[136:139], v[32:35]
    v_cvt_pk_bf16_f32 v49, v50, v51
    v_cvt_pk_bf16_f32 v50, v68, v69
    v_mfma_f32_16x16x32_bf16 v[52:55], v[116:119], v[124:127], v[52:55]
    v_cvt_pk_bf16_f32 v51, v70, v71
    v_mfma_f32_16x16x32_bf16 v[72:75], v[116:119], v[100:103], v[72:75]
    v_permlane16_swap_b32 v48, v50
    v_permlane16_swap_b32 v49, v51
    v_mfma_f32_16x16x32_bf16 v[52:55], v[96:99], v[80:83], v[52:55]
    buffer_store_dwordx4 v[48:51], v151, s[28:31], s47 offen sc1
    v_cvt_pk_bf16_f32 v12, v12, v13
    v_mfma_f32_16x16x32_bf16 v[72:75], v[96:99], v[120:123], v[72:75]
    v_cvt_pk_bf16_f32 v13, v14, v15
    v_cvt_pk_bf16_f32 v14, v32, v33
    s_waitcnt lgkmcnt(2)
    v_mfma_f32_16x16x32_bf16 v[16:19], v[112:115], v[104:107], v[16:19]
    v_cvt_pk_bf16_f32 v15, v34, v35
    v_mfma_f32_16x16x32_bf16 v[36:39], v[112:115], v[108:111], v[36:39]
    v_permlane16_swap_b32 v12, v14
    v_permlane16_swap_b32 v13, v15
    s_waitcnt lgkmcnt(0)
    v_mfma_f32_16x16x32_bf16 v[16:19], v[128:131], v[88:91], v[16:19]
    buffer_store_dwordx4 v[12:15], v151, s[28:31], s32 offen sc1
    v_cvt_pk_bf16_f32 v52, v52, v53
    v_mfma_f32_16x16x32_bf16 v[36:39], v[128:131], v[136:139], v[36:39]
    v_cvt_pk_bf16_f32 v53, v54, v55
    v_cvt_pk_bf16_f32 v54, v72, v73
    v_mfma_f32_16x16x32_bf16 v[56:59], v[112:115], v[124:127], v[56:59]
    v_cvt_pk_bf16_f32 v55, v74, v75
    v_mfma_f32_16x16x32_bf16 v[76:79], v[112:115], v[100:103], v[76:79]
    v_permlane16_swap_b32 v52, v54
    v_permlane16_swap_b32 v53, v55
    v_mfma_f32_16x16x32_bf16 v[56:59], v[128:131], v[80:83], v[56:59]
    buffer_store_dwordx4 v[52:55], v151, s[28:31], s33 offen sc1
    v_cvt_pk_bf16_f32 v16, v16, v17
    v_mfma_f32_16x16x32_bf16 v[76:79], v[128:131], v[120:123], v[76:79]
    v_cvt_pk_bf16_f32 v17, v18, v19
    v_cvt_pk_bf16_f32 v18, v36, v37
    v_cvt_pk_bf16_f32 v19, v38, v39
    buffer_store_dwordx4 v[16:19], v167, s[28:31], s26 offen offset:1024 sc1
    s_nop 3
    v_cvt_pk_bf16_f32 v56, v56, v57
    v_cvt_pk_bf16_f32 v57, v58, v59
    v_cvt_pk_bf16_f32 v58, v76, v77
    v_cvt_pk_bf16_f32 v59, v78, v79
    buffer_store_dwordx4 v[56:59], v167, s[28:31], s27 offen offset:1024 sc1
    s_cmp_eq_u32 s12, 0
    s_cbranch_scc1 P1_DONE
    s_mov_b32 s30, 15577088
    v_mov_b32 v88, 158776
    v_mov_b32 v89, 1
    s_mov_b64 exec, 1
    ds_add_u32 v88, v89 offset:0
    s_mov_b64 exec, -1
    s_mov_b32 s34, 1
    s_branch ATT
NU_QK:
    buffer_store_dwordx4 v[0:3], v151, s[28:31], s26 offen sc1
    buffer_store_dwordx4 v[40:43], v151, s[28:31], s27 offen sc1
    buffer_store_dwordx4 v[4:7], v151, s[28:31], s44 offen sc1
    buffer_store_dwordx4 v[44:47], v151, s[28:31], s45 offen sc1
    buffer_store_dwordx4 v[8:11], v151, s[28:31], s46 offen sc1
    buffer_store_dwordx4 v[48:51], v151, s[28:31], s47 offen sc1
    buffer_store_dwordx4 v[12:15], v151, s[28:31], s32 offen sc1
    buffer_store_dwordx4 v[52:55], v151, s[28:31], s33 offen sc1
    buffer_store_dwordx4 v[16:19], v167, s[28:31], s26 offen offset:1024 sc1
    buffer_store_dwordx4 v[56:59], v167, s[28:31], s27 offen offset:1024 sc1
    s_branch ATT_SIG
P1_PRE_V:
    s_lshl_b32 s26, s20, 1
    s_add_u32 s26, s26, s37
    s_mul_i32 s26, s26, 657408
    s_lshl_b32 s23, s21, 1
    s_add_u32 s23, s23, s36
    s_mul_i32 s23, s23, 5120
    s_add_u32 s26, s26, s23
    s_add_u32 s26, s26, 1280
    s_add_u32 s44, s26, 164352
    s_add_u32 s45, s26, 328704
    s_add_u32 s46, s26, 493056
    s_mov_b32 s35, 164352
    v_lshrrev_b32 v167, 5, v150
    v_mul_u32_u24 v167, 640, v167
    v_bfe_u32 v96, v150, 4, 1
    v_lshl_add_u32 v151, v96, 6, v167
    v_mul_u32_u24 v96, 384, v96
    v_add_u32 v167, v167, v96
    v_and_b32 v96, 15, v150
    v_lshl_add_u32 v167, v96, 4, v167
    v_and_b32 v96, 3, v150
    v_lshl_add_u32 v151, v96, 4, v151
    v_bfe_u32 v96, v150, 2, 2
    v_mul_lo_u32 v96, v96, s35
    v_add_u32 v151, v151, v96
P1_LOOP_V:
    s_waitcnt lgkmcnt(2)
    v_mfma_f32_16x16x32_bf16 v[4:7], v[80:83], v[120:123], v[4:7]
    v_cndmask_b32 v116, v116, v149, s[24:25]
    v_cndmask_b32 v117, v117, v149, s[24:25]
    v_xor_b32 v143, 64, v142
    v_mfma_f32_16x16x32_bf16 v[8:11], v[80:83], v[124:127], v[8:11]
    v_cndmask_b32 v118, v118, v149, s[24:25]
    v_cndmask_b32 v119, v119, v149, s[24:25]
    s_barrier
    v_mfma_f32_16x16x32_bf16 v[12:15], v[80:83], v[128:131], v[12:15]
    ds_read_b64_tr_b16 v[100:101], v145 offset:0
    v_mfma_f32_16x16x32_bf16 v[16:19], v[80:83], v[132:135], v[16:19]
    ds_read_b64_tr_b16 v[102:103], v145 offset:1280
    v_mfma_f32_16x16x32_bf16 v[0:3], v[80:83], v[116:119], v[0:3]
    ds_read_b128 v[80:83], v142 offset:0
    v_mfma_f32_16x16x32_bf16 v[24:27], v[84:87], v[120:123], v[24:27]
    ds_read_b64_tr_b16 v[104:105], v146 offset:0
    v_mfma_f32_16x16x32_bf16 v[28:31], v[84:87], v[124:127], v[28:31]
    ds_read_b64_tr_b16 v[106:107], v146 offset:1280
    v_mfma_f32_16x16x32_bf16 v[32:35], v[84:87], v[128:131], v[32:35]
    ds_read_b64_tr_b16 v[108:109], v147 offset:0
    v_mfma_f32_16x16x32_bf16 v[36:39], v[84:87], v[132:135], v[36:39]
    ds_read_b64_tr_b16 v[110:111], v147 offset:1280
    v_mfma_f32_16x16x32_bf16 v[20:23], v[84:87], v[116:119], v[20:23]
    ds_read_b128 v[84:87], v142 offset:2048
    s_waitcnt lgkmcnt(9)
    v_mfma_f32_16x16x32_bf16 v[44:47], v[88:91], v[120:123], v[44:47]
    ds_read_b64_tr_b16 v[112:113], v148 offset:0
    v_mfma_f32_16x16x32_bf16 v[48:51], v[88:91], v[124:127], v[48:51]
    ds_read_b64_tr_b16 v[114:115], v148 offset:1280
    v_mfma_f32_16x16x32_bf16 v[52:55], v[88:91], v[128:131], v[52:55]
    ds_read_b64_tr_b16 v[96:97], v144 offset:0
    v_mfma_f32_16x16x32_bf16 v[56:59], v[88:91], v[132:135], v[56:59]
    ds_read_b64_tr_b16 v[98:99], v144 offset:1280
    v_mfma_f32_16x16x32_bf16 v[40:43], v[88:91], v[116:119], v[40:43]
    ds_read_b128 v[88:91], v142 offset:4096
    s_waitcnt lgkmcnt(13)
    v_mfma_f32_16x16x32_bf16 v[64:67], v[92:95], v[120:123], v[64:67]
    v_mfma_f32_16x16x32_bf16 v[68:71], v[92:95], v[124:127], v[68:71]
    v_mfma_f32_16x16x32_bf16 v[72:75], v[92:95], v[128:131], v[72:75]
    v_mfma_f32_16x16x32_bf16 v[76:79], v[92:95], v[132:135], v[76:79]
    v_mfma_f32_16x16x32_bf16 v[60:63], v[92:95], v[116:119], v[60:63]
    ds_read_b128 v[92:95], v142 offset:6144
    s_waitcnt lgkmcnt(2)
    v_mfma_f32_16x16x32_bf16 v[4:7], v[80:83], v[100:103], v[4:7]
    v_cndmask_b32 v96, v96, v149, s[24:25]
    v_cndmask_b32 v97, v97, v149, s[24:25]
    ds_read_b64_tr_b16 v[120:121], v145 offset:10240
    v_mfma_f32_16x16x32_bf16 v[8:11], v[80:83], v[104:107], v[8:11]
    v_cndmask_b32 v98, v98, v149, s[24:25]
    v_cndmask_b32 v99, v99, v149, s[24:25]
    ds_read_b64_tr_b16 v[122:123], v145 offset:11520
    v_mfma_f32_16x16x32_bf16 v[12:15], v[80:83], v[108:111], v[12:15]
    ds_read_b64_tr_b16 v[124:125], v146 offset:10240
    v_mfma_f32_16x16x32_bf16 v[16:19], v[80:83], v[112:115], v[16:19]
    ds_read_b64_tr_b16 v[126:127], v146 offset:11520
    v_mfma_f32_16x16x32_bf16 v[0:3], v[80:83], v[96:99], v[0:3]
    ds_read_b128 v[80:83], v143 offset:0
    v_mfma_f32_16x16x32_bf16 v[24:27], v[84:87], v[100:103], v[24:27]
    ds_read_b64_tr_b16 v[128:129], v147 offset:10240
    v_mfma_f32_16x16x32_bf16 v[28:31], v[84:87], v[104:107], v[28:31]
    ds_read_b64_tr_b16 v[130:131], v147 offset:11520
    v_mfma_f32_16x16x32_bf16 v[32:35], v[84:87], v[108:111], v[32:35]
    ds_read_b64_tr_b16 v[132:133], v148 offset:10240
    v_mfma_f32_16x16x32_bf16 v[36:39], v[84:87], v[112:115], v[36:39]
    ds_read_b64_tr_b16 v[134:135], v148 offset:11520
    v_mfma_f32_16x16x32_bf16 v[20:23], v[84:87], v[96:99], v[20:23]
    ds_read_b128 v[84:87], v143 offset:2048
    s_waitcnt lgkmcnt(11)
    v_mfma_f32_16x16x32_bf16 v[44:47], v[88:91], v[100:103], v[44:47]
    ds_read_b64_tr_b16 v[116:117], v144 offset:10240
    v_mfma_f32_16x16x32_bf16 v[48:51], v[88:91], v[104:107], v[48:51]
    ds_read_b64_tr_b16 v[118:119], v144 offset:11520
    v_mfma_f32_16x16x32_bf16 v[52:55], v[88:91], v[108:111], v[52:55]
    s_add_u32 s40, s40, 1
    s_add_u32 s41, s40, 2
    v_mfma_f32_16x16x32_bf16 v[56:59], v[88:91], v[112:115], v[56:59]
    s_and_b32 s41, s41, 3
    s_mul_i32 s42, s41, 36864
    v_mfma_f32_16x16x32_bf16 v[40:43], v[88:91], v[96:99], v[40:43]
    ds_read_b128 v[88:91], v143 offset:4096
    s_waitcnt lgkmcnt(13)
    v_mfma_f32_16x16x32_bf16 v[64:67], v[92:95], v[100:103], v[64:67]
    v_add_u32 v142, s42, v136
    v_add_u32 v144, s42, v137
    v_mfma_f32_16x16x32_bf16 v[68:71], v[92:95], v[104:107], v[68:71]
    v_add_u32 v145, s42, v138
    v_add_u32 v146, s42, v139
    v_mfma_f32_16x16x32_bf16 v[72:75], v[92:95], v[108:111], v[72:75]
    v_add_u32 v147, s42, v140
    v_add_u32 v148, s42, v141
    v_mfma_f32_16x16x32_bf16 v[76:79], v[92:95], v[112:115], v[76:79]
    v_mfma_f32_16x16x32_bf16 v[60:63], v[92:95], v[96:99], v[60:63]
    ds_read_b128 v[92:95], v143 offset:6144
    s_cmp_lt_u32 s40, s43
    s_cbranch_scc1 P1_LOOP_V
    s_cmp_eq_u32 s22, 3
    s_cbranch_scc1 P1_EPI_DFT
    s_cmp_eq_u32 s12, 1
    s_cselect_b32 s30, 0, s30
    v_xor_b32 v143, 64, v142
    s_waitcnt lgkmcnt(0)
    s_barrier
    v_mfma_f32_16x16x32_bf16 v[4:7], v[80:83], v[120:123], v[4:7]
    ds_read_b64_tr_b16 v[96:97], v145 offset:0
    v_mfma_f32_16x16x32_bf16 v[8:11], v[80:83], v[124:127], v[8:11]
    ds_read_b64_tr_b16 v[98:99], v145 offset:1280
    v_mfma_f32_16x16x32_bf16 v[12:15], v[80:83], v[128:131], v[12:15]
    ds_read_b128 v[100:103], v142 offset:0
    v_mfma_f32_16x16x32_bf16 v[16:19], v[80:83], v[132:135], v[16:19]
    ds_read_b64_tr_b16 v[104:105], v146 offset:0
    v_mfma_f32_16x16x32_bf16 v[0:3], v[80:83], v[116:119], v[0:3]
    ds_read_b64_tr_b16 v[106:107], v146 offset:1280
    v_mfma_f32_16x16x32_bf16 v[24:27], v[84:87], v[120:123], v[24:27]
    ds_read_b64_tr_b16 v[108:109], v147 offset:0
    v_mfma_f32_16x16x32_bf16 v[28:31], v[84:87], v[124:127], v[28:31]
    ds_read_b64_tr_b16 v[110:111], v147 offset:1280
    v_mfma_f32_16x16x32_bf16 v[32:35], v[84:87], v[128:131], v[32:35]
    ds_read_b64_tr_b16 v[112:113], v148 offset:0
    v_mfma_f32_16x16x32_bf16 v[36:39], v[84:87], v[132:135], v[36:39]
    ds_read_b64_tr_b16 v[114:115], v148 offset:1280
    v_mfma_f32_16x16x32_bf16 v[20:23], v[84:87], v[116:119], v[20:23]
    ds_read_b64_tr_b16 v[136:137], v144 offset:0
    v_mfma_f32_16x16x32_bf16 v[44:47], v[88:91], v[120:123], v[44:47]
    ds_read_b64_tr_b16 v[138:139], v144 offset:1280
    v_mfma_f32_16x16x32_bf16 v[48:51], v[88:91], v[124:127], v[48:51]
    ds_read_b128 v[80:83], v142 offset:2048
    v_mfma_f32_16x16x32_bf16 v[52:55], v[88:91], v[128:131], v[52:55]
    ds_read_b128 v[84:87], v142 offset:4096
    v_mfma_f32_16x16x32_bf16 v[56:59], v[88:91], v[132:135], v[56:59]
    v_mfma_f32_16x16x32_bf16 v[40:43], v[88:91], v[116:119], v[40:43]
    ds_read_b128 v[88:91], v142 offset:6144
    v_mfma_f32_16x16x32_bf16 v[64:67], v[92:95], v[120:123], v[64:67]
    ds_read_b64_tr_b16 v[120:121], v145 offset:10240
    v_mfma_f32_16x16x32_bf16 v[68:71], v[92:95], v[124:127], v[68:71]
    ds_read_b64_tr_b16 v[122:123], v145 offset:11520
    v_mfma_f32_16x16x32_bf16 v[72:75], v[92:95], v[128:131], v[72:75]
    ds_read_b128 v[124:127], v143 offset:0
    v_mfma_f32_16x16x32_bf16 v[76:79], v[92:95], v[132:135], v[76:79]
    ds_read_b64_tr_b16 v[128:129], v146 offset:10240
    v_mfma_f32_16x16x32_bf16 v[60:63], v[92:95], v[116:119], v[60:63]
    ds_read_b64_tr_b16 v[130:131], v146 offset:11520
    s_waitcnt lgkmcnt(6)
    v_mfma_f32_16x16x32_bf16 v[4:7], v[100:103], v[96:99], v[4:7]
    ds_read_b64_tr_b16 v[132:133], v147 offset:10240
    v_mfma_f32_16x16x32_bf16 v[8:11], v[100:103], v[104:107], v[8:11]
    ds_read_b64_tr_b16 v[134:135], v147 offset:11520
    v_mfma_f32_16x16x32_bf16 v[12:15], v[100:103], v[108:111], v[12:15]
    ds_read_b64_tr_b16 v[92:93], v148 offset:10240
    v_mfma_f32_16x16x32_bf16 v[16:19], v[100:103], v[112:115], v[16:19]
    ds_read_b64_tr_b16 v[94:95], v148 offset:11520
    v_mfma_f32_16x16x32_bf16 v[0:3], v[100:103], v[136:139], v[0:3]
    ds_read_b64_tr_b16 v[116:117], v144 offset:10240
    v_mfma_f32_16x16x32_bf16 v[24:27], v[80:83], v[96:99], v[24:27]
    ds_read_b64_tr_b16 v[118:119], v144 offset:11520
    v_mfma_f32_16x16x32_bf16 v[28:31], v[80:83], v[104:107], v[28:31]
    ds_read_b128 v[100:103], v143 offset:2048
    v_mfma_f32_16x16x32_bf16 v[32:35], v[80:83], v[108:111], v[32:35]
    v_mfma_f32_16x16x32_bf16 v[36:39], v[80:83], v[112:115], v[36:39]
    v_mfma_f32_16x16x32_bf16 v[20:23], v[80:83], v[136:139], v[20:23]
    ds_read_b128 v[80:83], v143 offset:4096
    v_mfma_f32_16x16x32_bf16 v[44:47], v[84:87], v[96:99], v[44:47]
    v_mfma_f32_16x16x32_bf16 v[48:51], v[84:87], v[104:107], v[48:51]
    v_mfma_f32_16x16x32_bf16 v[52:55], v[84:87], v[108:111], v[52:55]
    v_mfma_f32_16x16x32_bf16 v[56:59], v[84:87], v[112:115], v[56:59]
    v_mfma_f32_16x16x32_bf16 v[40:43], v[84:87], v[136:139], v[40:43]
    ds_read_b128 v[84:87], v143 offset:6144
    s_waitcnt lgkmcnt(6)
    v_mfma_f32_16x16x32_bf16 v[64:67], v[88:91], v[96:99], v[64:67]
    s_barrier
    ds_read_b64_tr_b16 v[96:97], v144 offset:36864
    v_mfma_f32_16x16x32_bf16 v[68:71], v[88:91], v[104:107], v[68:71]
    ds_read_b64_tr_b16 v[98:99], v144 offset:38144
    v_mfma_f32_16x16x32_bf16 v[72:75], v[88:91], v[108:111], v[72:75]
    ds_read_b128 v[104:107], v142 offset:36864
    v_mfma_f32_16x16x32_bf16 v[76:79], v[88:91], v[112:115], v[76:79]
    ds_read_b128 v[108:111], v142 offset:38912
    v_mfma_f32_16x16x32_bf16 v[60:63], v[88:91], v[136:139], v[60:63]
    ds_read_b64_tr_b16 v[112:113], v144 offset:47104
    v_mfma_f32_16x16x32_bf16 v[4:7], v[124:127], v[120:123], v[4:7]
    ds_read_b64_tr_b16 v[114:115], v144 offset:48384
    v_mfma_f32_16x16x32_bf16 v[8:11], v[124:127], v[128:131], v[8:11]
    ds_read_b128 v[88:91], v143 offset:36864
    v_mfma_f32_16x16x32_bf16 v[12:15], v[124:127], v[132:135], v[12:15]
    ds_read_b128 v[136:139], v143 offset:38912
    s_waitcnt lgkmcnt(6)
    v_mfma_f32_16x16x32_bf16 v[16:19], v[124:127], v[92:95], v[16:19]
    v_mfma_f32_16x16x32_bf16 v[0:3], v[124:127], v[116:119], v[0:3]
    ds_read_b128 v[124:127], v142 offset:40960
    v_mfma_f32_16x16x32_bf16 v[24:27], v[100:103], v[120:123], v[24:27]
    v_mfma_f32_16x16x32_bf16 v[28:31], v[100:103], v[128:131], v[28:31]
    v_mfma_f32_16x16x32_bf16 v[32:35], v[100:103], v[132:135], v[32:35]
    v_mfma_f32_16x16x32_bf16 v[36:39], v[100:103], v[92:95], v[36:39]
    v_mfma_f32_16x16x32_bf16 v[20:23], v[100:103], v[116:119], v[20:23]
    ds_read_b128 v[100:103], v142 offset:43008
    v_mfma_f32_16x16x32_bf16 v[44:47], v[80:83], v[120:123], v[44:47]
    v_mfma_f32_16x16x32_bf16 v[48:51], v[80:83], v[128:131], v[48:51]
    v_mfma_f32_16x16x32_bf16 v[52:55], v[80:83], v[132:135], v[52:55]
    v_mfma_f32_16x16x32_bf16 v[56:59], v[80:83], v[92:95], v[56:59]
    v_mfma_f32_16x16x32_bf16 v[40:43], v[80:83], v[116:119], v[40:43]
    ds_read_b128 v[80:83], v143 offset:40960
    v_mfma_f32_16x16x32_bf16 v[64:67], v[84:87], v[120:123], v[64:67]
    ds_read_b128 v[120:123], v143 offset:43008
    v_mfma_f32_16x16x32_bf16 v[68:71], v[84:87], v[128:131], v[68:71]
    ds_read_b64_tr_b16 v[128:129], v145 offset:36864
    v_mfma_f32_16x16x32_bf16 v[72:75], v[84:87], v[132:135], v[72:75]
    ds_read_b64_tr_b16 v[130:131], v145 offset:38144
    v_mfma_f32_16x16x32_bf16 v[76:79], v[84:87], v[92:95], v[76:79]
    ds_read_b64_tr_b16 v[132:133], v145 offset:47104
    v_mfma_f32_16x16x32_bf16 v[60:63], v[84:87], v[116:119], v[60:63]
    ds_read_b64_tr_b16 v[134:135], v145 offset:48384
    s_waitcnt lgkmcnt(6)
    v_mfma_f32_16x16x32_bf16 v[0:3], v[104:107], v[96:99], v[0:3]
    ds_read_b64_tr_b16 v[92:93], v146 offset:36864
    v_mfma_f32_16x16x32_bf16 v[20:23], v[108:111], v[96:99], v[20:23]
    ds_read_b64_tr_b16 v[94:95], v146 offset:38144
    v_mfma_f32_16x16x32_bf16 v[0:3], v[88:91], v[112:115], v[0:3]
    ds_read_b64_tr_b16 v[84:85], v146 offset:47104
    v_mfma_f32_16x16x32_bf16 v[20:23], v[136:139], v[112:115], v[20:23]
    ds_read_b64_tr_b16 v[86:87], v146 offset:48384
    v_mfma_f32_16x16x32_bf16 v[40:43], v[124:127], v[96:99], v[40:43]
    ds_read_b64_tr_b16 v[116:117], v147 offset:36864
    v_mfma_f32_16x16x32_bf16 v[60:63], v[100:103], v[96:99], v[60:63]
    ds_read_b64_tr_b16 v[118:119], v147 offset:38144
    s_waitcnt lgkmcnt(6)
    v_mfma_f32_16x16x32_bf16 v[40:43], v[80:83], v[112:115], v[40:43]
    ds_read_b64_tr_b16 v[96:97], v147 offset:47104
    v_cvt_pk_bf16_f32 v0, v0, v1
    v_cvt_pk_bf16_f32 v1, v2, v3
    v_mfma_f32_16x16x32_bf16 v[60:63], v[120:123], v[112:115], v[60:63]
    ds_read_b64_tr_b16 v[98:99], v147 offset:48384
    v_cvt_pk_bf16_f32 v2, v20, v21
    v_cvt_pk_bf16_f32 v3, v22, v23
    v_mfma_f32_16x16x32_bf16 v[4:7], v[104:107], v[128:131], v[4:7]
    ds_read_b64_tr_b16 v[112:113], v148 offset:36864
    buffer_store_dwordx4 v[0:3], v167, s[28:31], s26 offen offset:0 sc1
    v_mfma_f32_16x16x32_bf16 v[24:27], v[108:111], v[128:131], v[24:27]
    ds_read_b64_tr_b16 v[114:115], v148 offset:38144
    v_cvt_pk_bf16_f32 v40, v40, v41
    v_cvt_pk_bf16_f32 v41, v42, v43
    v_mfma_f32_16x16x32_bf16 v[4:7], v[88:91], v[132:135], v[4:7]
    v_cvt_pk_bf16_f32 v42, v60, v61
    v_cvt_pk_bf16_f32 v43, v62, v63
    v_mfma_f32_16x16x32_bf16 v[24:27], v[136:139], v[132:135], v[24:27]
    buffer_store_dwordx4 v[40:43], v167, s[28:31], s26 offen offset:2560 sc1
    v_mfma_f32_16x16x32_bf16 v[44:47], v[124:127], v[128:131], v[44:47]
    v_mfma_f32_16x16x32_bf16 v[64:67], v[100:103], v[128:131], v[64:67]
    ds_read_b64_tr_b16 v[128:129], v148 offset:47104
    v_mfma_f32_16x16x32_bf16 v[44:47], v[80:83], v[132:135], v[44:47]
    ds_read_b64_tr_b16 v[130:131], v148 offset:48384
    v_mfma_f32_16x16x32_bf16 v[64:67], v[120:123], v[132:135], v[64:67]
    s_waitcnt lgkmcnt(6)
    v_mfma_f32_16x16x32_bf16 v[8:11], v[104:107], v[92:95], v[8:11]
    v_cvt_pk_bf16_f32 v4, v4, v5
    v_cvt_pk_bf16_f32 v5, v6, v7
    v_mfma_f32_16x16x32_bf16 v[28:31], v[108:111], v[92:95], v[28:31]
    v_cvt_pk_bf16_f32 v6, v24, v25
    v_cvt_pk_bf16_f32 v7, v26, v27
    v_mfma_f32_16x16x32_bf16 v[8:11], v[88:91], v[84:87], v[8:11]
    buffer_store_dwordx4 v[4:7], v167, s[28:31], s44 offen offset:0 sc1
    v_cvt_pk_bf16_f32 v44, v44, v45
    v_mfma_f32_16x16x32_bf16 v[28:31], v[136:139], v[84:87], v[28:31]
    v_cvt_pk_bf16_f32 v45, v46, v47
    v_cvt_pk_bf16_f32 v46, v64, v65
    v_mfma_f32_16x16x32_bf16 v[48:51], v[124:127], v[92:95], v[48:51]
    v_cvt_pk_bf16_f32 v47, v66, v67
    buffer_store_dwordx4 v[44:47], v167, s[28:31], s44 offen offset:2560 sc1
    v_mfma_f32_16x16x32_bf16 v[68:71], v[100:103], v[92:95], v[68:71]
    v_mfma_f32_16x16x32_bf16 v[48:51], v[80:83], v[84:87], v[48:51]
    v_mfma_f32_16x16x32_bf16 v[68:71], v[120:123], v[84:87], v[68:71]
    v_cvt_pk_bf16_f32 v8, v8, v9
    v_cvt_pk_bf16_f32 v9, v10, v11
    v_mfma_f32_16x16x32_bf16 v[12:15], v[104:107], v[116:119], v[12:15]
    v_cvt_pk_bf16_f32 v10, v28, v29
    v_cvt_pk_bf16_f32 v11, v30, v31
    v_mfma_f32_16x16x32_bf16 v[32:35], v[108:111], v[116:119], v[32:35]
    buffer_store_dwordx4 v[8:11], v167, s[28:31], s45 offen offset:0 sc1
    s_waitcnt lgkmcnt(4)
    v_mfma_f32_16x16x32_bf16 v[12:15], v[88:91], v[96:99], v[12:15]
    v_cvt_pk_bf16_f32 v48, v48, v49
    v_cvt_pk_bf16_f32 v49, v50, v51
    v_mfma_f32_16x16x32_bf16 v[32:35], v[136:139], v[96:99], v[32:35]
    v_cvt_pk_bf16_f32 v50, v68, v69
    v_cvt_pk_bf16_f32 v51, v70, v71
    v_mfma_f32_16x16x32_bf16 v[52:55], v[124:127], v[116:119], v[52:55]
    buffer_store_dwordx4 v[48:51], v167, s[28:31], s45 offen offset:2560 sc1
    v_mfma_f32_16x16x32_bf16 v[72:75], v[100:103], v[116:119], v[72:75]
    v_mfma_f32_16x16x32_bf16 v[52:55], v[80:83], v[96:99], v[52:55]
    v_mfma_f32_16x16x32_bf16 v[72:75], v[120:123], v[96:99], v[72:75]
    s_waitcnt lgkmcnt(2)
    v_mfma_f32_16x16x32_bf16 v[16:19], v[104:107], v[112:115], v[16:19]
    v_cvt_pk_bf16_f32 v12, v12, v13
    v_cvt_pk_bf16_f32 v13, v14, v15
    v_mfma_f32_16x16x32_bf16 v[36:39], v[108:111], v[112:115], v[36:39]
    v_cvt_pk_bf16_f32 v14, v32, v33
    v_cvt_pk_bf16_f32 v15, v34, v35
    s_waitcnt lgkmcnt(0)
    v_mfma_f32_16x16x32_bf16 v[16:19], v[88:91], v[128:131], v[16:19]
    buffer_store_dwordx4 v[12:15], v167, s[28:31], s46 offen offset:0 sc1
    v_cvt_pk_bf16_f32 v52, v52, v53
    v_mfma_f32_16x16x32_bf16 v[36:39], v[136:139], v[128:131], v[36:39]
    v_cvt_pk_bf16_f32 v53, v54, v55
    v_cvt_pk_bf16_f32 v54, v72, v73
    v_mfma_f32_16x16x32_bf16 v[56:59], v[124:127], v[112:115], v[56:59]
    v_cvt_pk_bf16_f32 v55, v74, v75
    buffer_store_dwordx4 v[52:55], v167, s[28:31], s46 offen offset:2560 sc1
    v_mfma_f32_16x16x32_bf16 v[76:79], v[100:103], v[112:115], v[76:79]
    v_mfma_f32_16x16x32_bf16 v[56:59], v[80:83], v[128:131], v[56:59]
    v_mfma_f32_16x16x32_bf16 v[76:79], v[120:123], v[128:131], v[76:79]
    v_cvt_pk_bf16_f32 v16, v16, v17
    v_cvt_pk_bf16_f32 v17, v18, v19
    v_cvt_pk_bf16_f32 v18, v36, v37
    v_cvt_pk_bf16_f32 v19, v38, v39
    buffer_store_dwordx4 v[16:19], v151, s[28:31], s26 offen offset:256 sc1
    s_nop 2
    v_cvt_pk_bf16_f32 v56, v56, v57
    v_cvt_pk_bf16_f32 v57, v58, v59
    v_cvt_pk_bf16_f32 v58, v76, v77
    v_cvt_pk_bf16_f32 v59, v78, v79
    buffer_store_dwordx4 v[56:59], v151, s[28:31], s26 offen offset:2816 sc1
    s_cmp_eq_u32 s12, 0
    s_cbranch_scc1 P1_DONE
    s_mov_b32 s30, 15577088
    v_mov_b32 v88, 158776
    v_mov_b32 v89, 1
    s_mov_b64 exec, 1
    ds_add_u32 v88, v89 offset:0
    s_mov_b64 exec, -1
    s_mov_b32 s34, 1
    s_branch ATT
NU_V:
    buffer_store_dwordx4 v[0:3], v167, s[28:31], s26 offen offset:0 sc1
    buffer_store_dwordx4 v[40:43], v167, s[28:31], s26 offen offset:2560 sc1
    buffer_store_dwordx4 v[4:7], v167, s[28:31], s44 offen offset:0 sc1
    buffer_store_dwordx4 v[44:47], v167, s[28:31], s44 offen offset:2560 sc1
    buffer_store_dwordx4 v[8:11], v167, s[28:31], s45 offen offset:0 sc1
    buffer_store_dwordx4 v[48:51], v167, s[28:31], s45 offen offset:2560 sc1
    buffer_store_dwordx4 v[12:15], v167, s[28:31], s46 offen offset:0 sc1
    buffer_store_dwordx4 v[52:55], v167, s[28:31], s46 offen offset:2560 sc1
    buffer_store_dwordx4 v[16:19], v151, s[28:31], s26 offen offset:256 sc1
    buffer_store_dwordx4 v[56:59], v151, s[28:31], s26 offen offset:2816 sc1
    s_branch ATT_SIG
P1_EPI_DFT:
    s_waitcnt lgkmcnt(0)
    v_mfma_f32_16x16x32_bf16 v[4:7], v[80:83], v[120:123], v[4:7]
    v_cndmask_b32 v116, v116, v149, s[24:25]
    v_cndmask_b32 v117, v117, v149, s[24:25]
    v_mfma_f32_16x16x32_bf16 v[8:11], v[80:83], v[124:127], v[8:11]
    v_cndmask_b32 v118, v118, v149, s[24:25]
    v_cndmask_b32 v119, v119, v149, s[24:25]
    v_mfma_f32_16x16x32_bf16 v[12:15], v[80:83], v[128:131], v[12:15]
    v_mfma_f32_16x16x32_bf16 v[16:19], v[80:83], v[132:135], v[16:19]
    v_mfma_f32_16x16x32_bf16 v[0:3], v[80:83], v[116:119], v[0:3]
    v_mfma_f32_16x16x32_bf16 v[24:27], v[84:87], v[120:123], v[24:27]
    v_mfma_f32_16x16x32_bf16 v[28:31], v[84:87], v[124:127], v[28:31]
    v_mfma_f32_16x16x32_bf16 v[32:35], v[84:87], v[128:131], v[32:35]
    v_mfma_f32_16x16x32_bf16 v[36:39], v[84:87], v[132:135], v[36:39]
    v_mfma_f32_16x16x32_bf16 v[20:23], v[84:87], v[116:119], v[20:23]
    v_mfma_f32_16x16x32_bf16 v[44:47], v[88:91], v[120:123], v[44:47]
    v_mfma_f32_16x16x32_bf16 v[48:51], v[88:91], v[124:127], v[48:51]
    v_mfma_f32_16x16x32_bf16 v[52:55], v[88:91], v[128:131], v[52:55]
    v_mfma_f32_16x16x32_bf16 v[56:59], v[88:91], v[132:135], v[56:59]
    v_mfma_f32_16x16x32_bf16 v[40:43], v[88:91], v[116:119], v[40:43]
    v_mfma_f32_16x16x32_bf16 v[64:67], v[92:95], v[120:123], v[64:67]
    v_mfma_f32_16x16x32_bf16 v[68:71], v[92:95], v[124:127], v[68:71]
    v_mfma_f32_16x16x32_bf16 v[72:75], v[92:95], v[128:131], v[72:75]
    v_mfma_f32_16x16x32_bf16 v[76:79], v[92:95], v[132:135], v[76:79]
    v_mfma_f32_16x16x32_bf16 v[60:63], v[92:95], v[116:119], v[60:63]
    s_cmp_lt_u32 s20, 2
    s_cselect_b32 s38, 1.0, -1.0
    v_mov_b32 v80, s38
    v_cndmask_b32 v81, v80, 1.0, s[24:25]
    s_lshl_b32 s26, s20, 1
    s_add_u32 s26, s26, s37
    s_mul_i32 s26, s26, 80
    v_and_b32 v88, 15, v150
    v_add_u32 v140, s26, v88
    v_add_u32 v141, 20, v140
    v_add_u32 v142, 40, v140
    v_add_u32 v143, 60, v140
    v_and_b32 v89, 12, v150
    v_lshl_add_u32 v144, v89, 2, v140
    v_add_u32 v144, 16, v144
    s_lshl_b32 s23, s21, 1
    s_add_u32 s23, s23, s36
    s_cmp_lg_u32 s23, 0
    s_cbranch_scc1 P1_EPI_DFT2
    s_mov_b64 exec, 0xffff
    s_mov_b32 s27, 9207808
    v_fma_f32 v96, v60, v81, v20
    v_lshlrev_b32 v104, 2, v140
    v_mov_b32 v20, 0
    v_mov_b32 v60, 0
    buffer_store_dword v96, v104, s[28:31], s27 offen sc1
    v_fma_f32 v97, v64, v80, v24
    v_lshlrev_b32 v105, 2, v141
    v_mov_b32 v24, 0
    v_mov_b32 v64, 0
    buffer_store_dword v97, v105, s[28:31], s27 offen sc1
    v_fma_f32 v98, v68, v80, v28
    v_lshlrev_b32 v106, 2, v142
    v_mov_b32 v28, 0
    v_mov_b32 v68, 0
    buffer_store_dword v98, v106, s[28:31], s27 offen sc1
    v_fma_f32 v99, v72, v80, v32
    v_lshlrev_b32 v107, 2, v143
    v_mov_b32 v32, 0
    v_mov_b32 v72, 0
    buffer_store_dword v99, v107, s[28:31], s27 offen sc1
    v_fma_f32 v100, v76, v80, v36
    v_lshlrev_b32 v108, 2, v144
    v_mov_b32 v36, 0
    v_mov_b32 v76, 0
    buffer_store_dword v100, v108, s[28:31], s27 offen sc1
    s_mov_b64 exec, -1
P1_EPI_DFT2:
    s_lshl_b32 s26, s23, 9
    s_add_u32 s26, s26, 7897088
    s_mov_b32 s27, 655360
    v_bfe_u32 v88, v150, 4, 1
    v_mul_lo_u32 v88, v88, s27
    v_lshrrev_b32 v89, 5, v150
    v_lshl_add_u32 v88, v89, 8, v88
    v_fma_f32 v0, v20, v81, v0
    v_fma_f32 v60, v40, v81, v60
    v_fma_f32 v1, v21, v81, v1
    v_fma_f32 v61, v41, v81, v61
    v_fma_f32 v2, v22, v81, v2
    v_fma_f32 v62, v42, v81, v62
    v_fma_f32 v3, v23, v81, v3
    v_fma_f32 v63, v43, v81, v63
    v_add_f32 v20, v0, v60
    v_sub_f32 v40, v0, v60
    v_add_f32 v21, v1, v61
    v_sub_f32 v41, v1, v61
    v_add_f32 v22, v2, v62
    v_sub_f32 v42, v2, v62
    v_add_f32 v23, v3, v63
    v_sub_f32 v43, v3, v63
    v_cvt_pk_bf16_f32 v0, v20, v21
    v_cvt_pk_bf16_f32 v1, v22, v23
    v_cvt_pk_bf16_f32 v2, v40, v41
    v_cvt_pk_bf16_f32 v3, v42, v43
    v_lshrrev_b32 v89, 4, v140
    v_lshl_add_u32 v89, v89, 14, v88
    v_and_b32 v140, 15, v140
    v_lshl_add_u32 v140, v140, 4, v89
    v_permlane16_swap_b32 v0, v2
    v_permlane16_swap_b32 v1, v3
    v_fma_f32 v4, v24, v80, v4
    v_fma_f32 v64, v44, v80, v64
    v_fma_f32 v5, v25, v80, v5
    v_fma_f32 v65, v45, v80, v65
    v_fma_f32 v6, v26, v80, v6
    v_fma_f32 v66, v46, v80, v66
    v_fma_f32 v7, v27, v80, v7
    v_fma_f32 v67, v47, v80, v67
    v_add_f32 v24, v4, v64
    v_sub_f32 v44, v4, v64
    v_add_f32 v25, v5, v65
    v_sub_f32 v45, v5, v65
    v_add_f32 v26, v6, v66
    v_sub_f32 v46, v6, v66
    v_add_f32 v27, v7, v67
    v_sub_f32 v47, v7, v67
    v_cvt_pk_bf16_f32 v4, v24, v25
    v_cvt_pk_bf16_f32 v5, v26, v27
    v_cvt_pk_bf16_f32 v6, v44, v45
    v_cvt_pk_bf16_f32 v7, v46, v47
    v_lshrrev_b32 v89, 4, v141
    v_lshl_add_u32 v89, v89, 14, v88
    v_and_b32 v141, 15, v141
    v_lshl_add_u32 v141, v141, 4, v89
    v_permlane16_swap_b32 v4, v6
    v_permlane16_swap_b32 v5, v7
    v_fma_f32 v8, v28, v80, v8
    v_fma_f32 v68, v48, v80, v68
    v_fma_f32 v9, v29, v80, v9
    v_fma_f32 v69, v49, v80, v69
    v_fma_f32 v10, v30, v80, v10
    v_fma_f32 v70, v50, v80, v70
    v_fma_f32 v11, v31, v80, v11
    v_fma_f32 v71, v51, v80, v71
    v_add_f32 v28, v8, v68
    v_sub_f32 v48, v8, v68
    v_add_f32 v29, v9, v69
    v_sub_f32 v49, v9, v69
    v_add_f32 v30, v10, v70
    v_sub_f32 v50, v10, v70
    v_add_f32 v31, v11, v71
    v_sub_f32 v51, v11, v71
    v_cvt_pk_bf16_f32 v8, v28, v29
    v_cvt_pk_bf16_f32 v9, v30, v31
    v_cvt_pk_bf16_f32 v10, v48, v49
    v_cvt_pk_bf16_f32 v11, v50, v51
    v_lshrrev_b32 v89, 4, v142
    v_lshl_add_u32 v89, v89, 14, v88
    v_and_b32 v142, 15, v142
    v_lshl_add_u32 v142, v142, 4, v89
    v_permlane16_swap_b32 v8, v10
    v_permlane16_swap_b32 v9, v11
    v_fma_f32 v12, v32, v80, v12
    v_fma_f32 v72, v52, v80, v72
    v_fma_f32 v13, v33, v80, v13
    v_fma_f32 v73, v53, v80, v73
    v_fma_f32 v14, v34, v80, v14
    v_fma_f32 v74, v54, v80, v74
    v_fma_f32 v15, v35, v80, v15
    v_fma_f32 v75, v55, v80, v75
    v_add_f32 v32, v12, v72
    v_sub_f32 v52, v12, v72
    v_add_f32 v33, v13, v73
    v_sub_f32 v53, v13, v73
    v_add_f32 v34, v14, v74
    v_sub_f32 v54, v14, v74
    v_add_f32 v35, v15, v75
    v_sub_f32 v55, v15, v75
    v_cvt_pk_bf16_f32 v12, v32, v33
    v_cvt_pk_bf16_f32 v13, v34, v35
    v_cvt_pk_bf16_f32 v14, v52, v53
    v_cvt_pk_bf16_f32 v15, v54, v55
    v_lshrrev_b32 v89, 4, v143
    v_lshl_add_u32 v89, v89, 14, v88
    v_and_b32 v143, 15, v143
    v_lshl_add_u32 v143, v143, 4, v89
    v_permlane16_swap_b32 v12, v14
    v_permlane16_swap_b32 v13, v15
    v_fma_f32 v16, v36, v80, v16
    v_fma_f32 v76, v56, v80, v76
    v_fma_f32 v17, v37, v80, v17
    v_fma_f32 v77, v57, v80, v77
    v_fma_f32 v18, v38, v80, v18
    v_fma_f32 v78, v58, v80, v78
    v_fma_f32 v19, v39, v80, v19
    v_fma_f32 v79, v59, v80, v79
    v_add_f32 v36, v16, v76
    v_sub_f32 v56, v16, v76
    v_add_f32 v37, v17, v77
    v_sub_f32 v57, v17, v77
    v_add_f32 v38, v18, v78
    v_sub_f32 v58, v18, v78
    v_add_f32 v39, v19, v79
    v_sub_f32 v59, v19, v79
    v_cvt_pk_bf16_f32 v16, v36, v37
    v_cvt_pk_bf16_f32 v17, v38, v39
    v_cvt_pk_bf16_f32 v18, v56, v57
    v_cvt_pk_bf16_f32 v19, v58, v59
    v_lshrrev_b32 v89, 4, v144
    v_lshl_add_u32 v89, v89, 14, v88
    v_and_b32 v144, 15, v144
    v_lshl_add_u32 v144, v144, 4, v89
    v_permlane16_swap_b32 v16, v18
    v_permlane16_swap_b32 v17, v19
    v_mov_b32 v88, 158776
    v_mov_b32 v89, 1
    s_mov_b32 s12, 1
    s_mov_b64 exec, 1
    ds_add_u32 v88, v89 offset:0
    s_mov_b64 exec, -1
    s_mov_b32 s34, 1
    s_branch ATT
NU_D:
    buffer_store_dwordx4 v[0:3], v140, s[28:31], s26 offen sc1
    buffer_store_dwordx4 v[4:7], v141, s[28:31], s26 offen sc1
    buffer_store_dwordx4 v[8:11], v142, s[28:31], s26 offen sc1
    buffer_store_dwordx4 v[12:15], v143, s[28:31], s26 offen sc1
    buffer_store_dwordx4 v[16:19], v144, s[28:31], s26 offen sc1
    s_branch ATT_SIG
P1_DONE:
    s_mov_b32 s34, 0
    v_mov_b32 v84, 1
    v_mov_b32 v85, 1
    v_mov_b32 v86, 1
    v_mov_b32 v87, 1
    v_mov_b32 v88, 158764
    v_mov_b32 v89, 0
    s_and_b32 s23, s15, -128
    s_mov_b64 exec, 1
    s_waitcnt vmcnt(0)
    ds_add_rtn_u32 v88, v88, v84
    s_waitcnt lgkmcnt(0)
    v_cmp_eq_u32 vcc, 3, v88
    s_cbranch_vccz P1_NS
    buffer_store_dwordx4 v[84:87], v89, s[28:31], s23 offen sc1
P1_NS:
    s_mov_b64 exec, -1
    s_branch ATT
P1_EXTRA:
    s_sub_u32 s61, s16, 8
    s_cmp_lg_u32 s16, 10
    s_cbranch_scc1 P1_NOCW
    s_lshl_b32 s23, s18, 10
    s_cmp_ge_u32 s23, L_CODE_END - gated_mix__spectral_fnet__softmax_full_mha__prompt_kernel - 1023
    s_cbranch_scc1 P1_NOCW
    s_getpc_b64 s[44:45]
L_PC:
    s_sub_u32 s44, s44, L_PC - gated_mix__spectral_fnet__softmax_full_mha__prompt_kernel
    s_subb_u32 s45, s45, 0
    v_lshl_add_u32 v40, v0, 4, s23
    global_load_dwordx4 v[44:47], v40, s[44:45]
P1_NOCW:
    v_lshrrev_b32 v37, 4, v0
    v_and_b32 v38, 15, v0
    v_lshlrev_b32 v39, 4, v0
    v_mov_b32 v36, v0
    s_waitcnt lgkmcnt(0)
    s_mov_b32 s28, s58
    s_mov_b32 s29, s59
    s_mov_b32 s30, 15577088
    s_mov_b32 s31, 0x20000
    s_mov_b32 s32, s56
    s_mov_b32 s33, s57
    s_mov_b32 s34, 256
    s_mov_b32 s35, 0x20000
    s_cmp_lg_u32 s61, 0
    s_cbranch_scc1 P1_EX_A
    v_mov_b32 v1, 0
    v_lshlrev_b32 v2, 2, v0
    v_add_u32 v2, 158720, v2
    ds_write_b32 v2, v1
    s_waitcnt lgkmcnt(0)
    s_cmp_lt_u32 s2, 248
    s_cbranch_scc1 P1_EX_WAITRDY
    v_mov_b32 v4, 0
    v_mov_b32 v5, 0
    v_mov_b32 v6, 0
    v_mov_b32 v7, 0
    s_lshl_b32 s23, s17, 12
    s_add_u32 s23, s23, 15536128
    buffer_store_dwordx4 v[4:7], v39, s[28:31], s23 offen sc1
    buffer_store_dwordx4 v[4:7], v39, s[28:31], s23 offen offset:1024 sc1
    buffer_store_dwordx4 v[4:7], v39, s[28:31], s23 offen offset:2048 sc1
    buffer_store_dwordx4 v[4:7], v39, s[28:31], s23 offen offset:3072 sc1
    s_lshl_b32 s23, s17, 10
    s_add_u32 s23, s23, 15568896
    buffer_store_dwordx4 v[4:7], v39, s[28:31], s23 offen sc1
P1_EX_WAITRDY:
P1_EX_A:
    s_lshl_b32 s23, s2, 2
    s_add_u32 s23, s23, s61
    s_mov_b32 s40, 0
P1_TBL:
    s_lshr_b32 s24, s23, 5
    s_and_b32 s25, s23, 30
    s_and_b32 s26, s24, 1
    s_lshr_b32 s27, s24, 1
    s_lshl_b32 s27, s27, 6
    s_add_u32 s27, s27, s26
    s_and_b32 s26, s23, 1
    s_lshl_b32 s26, s26, 5
    s_add_u32 s27, s27, s26
    v_lshl_add_u32 v40, v38, 1, s27
    s_lshl_b32 s25, s25, 4
    v_lshl_add_u32 v41, v37, 3, s25
    v_mul_u32_u24 v41, v40, v41
    v_and_b32 v41, 0x7ff, v41
    v_cvt_f32_u32 v40, v40
    v_cvt_f32_u32 v41, v41
    v_mul_f32 v40, 0x3a000000, v40
    v_mul_f32 v0, 0x3a000000, v41
    v_add_f32 v1, v0, v40
    v_add_f32 v2, v1, v40
    v_add_f32 v3, v2, v40
    v_add_f32 v4, v3, v40
    v_add_f32 v5, v4, v40
    v_add_f32 v6, v5, v40
    v_add_f32 v7, v6, v40
    v_fract_f32 v1, v1
    v_fract_f32 v2, v2
    v_fract_f32 v3, v3
    v_fract_f32 v4, v4
    v_fract_f32 v5, v5
    v_fract_f32 v6, v6
    v_fract_f32 v7, v7
    v_cos_f32 v8, v0
    v_cos_f32 v9, v1
    v_cos_f32 v10, v2
    v_cos_f32 v11, v3
    v_cos_f32 v12, v4
    v_cos_f32 v13, v5
    v_cos_f32 v14, v6
    v_cos_f32 v15, v7
    v_sin_f32 v16, v0
    v_sin_f32 v17, v1
    v_sin_f32 v18, v2
    v_sin_f32 v19, v3
    v_sin_f32 v20, v4
    v_sin_f32 v21, v5
    v_sin_f32 v22, v6
    v_sin_f32 v23, v7
    v_cvt_pk_bf16_f32 v24, v8, v9
    v_cvt_pk_bf16_f32 v25, v10, v11
    v_cvt_pk_bf16_f32 v26, v12, v13
    v_cvt_pk_bf16_f32 v27, v14, v15
    v_cvt_pk_bf16_f32 v28, v16, v17
    v_cvt_pk_bf16_f32 v29, v18, v19
    v_cvt_pk_bf16_f32 v30, v20, v21
    v_cvt_pk_bf16_f32 v31, v22, v23
    s_cmp_lg_u32 s40, 0
    s_cbranch_scc1 P1_TBL_ST
    s_barrier
    s_cmp_lg_u32 s61, 0
    s_cbranch_scc1 P1_EX_NR
    s_cmp_lt_u32 s2, 248
    s_cbranch_scc1 P1_EX_NR
    v_mov_b32 v32, 1
    v_mov_b32 v33, 0
    s_lshl_b32 s24, s17, 2
    s_waitcnt vmcnt(0)
    s_mov_b64 exec, 1
    buffer_store_dword v32, v33, s[32:35], s24 offen sc1
    s_mov_b64 exec, -1
P1_EX_NR:
    s_barrier
    s_mov_b32 s40, 1
P1_TBL_ST:
    s_lshl_b32 s24, s23, 11
    s_add_u32 s24, s24, 9211904
    buffer_store_dwordx4 v[24:27], v39, s[28:31], s24 offen sc1
    buffer_store_dwordx4 v[28:31], v39, s[28:31], s24 offen offset:1024 sc1
    s_add_u32 s23, s23, 1024
    s_cmp_lt_u32 s23, 1056
    s_cbranch_scc1 P1_TBL
    s_barrier
    s_barrier
    s_barrier
    s_barrier
    v_and_b32 v1, 7, v36
    v_lshlrev_b32 v1, 2, v1
    v_mov_b32 v2, 1
    s_mov_b32 s60, 0
    s_cmp_lg_u32 s61, 0
    s_cbranch_scc1 P1_EX_C
    buffer_load_dword v2, v1, s[32:35], 0 offen sc1
P1_EX_C:
    s_barrier
    s_barrier
L_RDY1:
    s_waitcnt vmcnt(0)
    v_cmp_eq_u32 vcc, 0, v2
    s_cbranch_vccz P1_EX_B
    s_sleep 1
    buffer_load_dword v2, v1, s[32:35], 0 offen sc1
    s_add_u32 s60, s60, 1
    s_cmp_lt_u32 s60, 0x40000
    s_cbranch_scc1 L_RDY1
P1_EX_B:
    s_waitcnt vmcnt(0)
    s_barrier
    s_barrier
    s_mov_b32 s34, 0
ATT:
    s_cmp_lt_u32 s13, 4
    s_cselect_b32 s40, 4, 4
    s_cselect_b32 s41, 7, 6
    s_movk_i32 s35, 0x10a
    s_bitset1_b32 s35, s40
    s_bitset1_b32 s35, s41
    s_mov_b32 s24, 0xfffff
    s_mov_b32 s25, 0xfffff
    s_mul_i32 s39, s13, 1280
    s_add_u32 s39, s39, 71680
    v_mov_b32 v61, 0
    v_mov_b32 v63, 0x3f803f80
    v_add_u32 v80, s39, v152
    v_add_u32 v81, s39, v153
    v_mov_b32 v82, 1
    s_xor_b32 s36, s13, 1
    s_mul_i32 s39, s36, 1280
    s_add_u32 s39, s39, 71680
    v_add_u32 v106, s39, v152
    v_add_u32 v107, s39, v153
    v_mov_b32 v108, v152
    v_mov_b32 v109, v153
    v_mov_b32 v105, 0
    s_mov_b32 s42, 0x3ea52b5c
    s_mov_b32 s43, s42
    s_and_b32 s37, s13, 1
    s_mul_i32 s37, s37, 2560
    v_and_b32 v110, 0x70, v163
    v_lshrrev_b32 v110, 2, v110
    v_add_u32 v110, 158720, v110
    s_lshl_b32 s23, s13, 12
    s_add_u32 s23, s23, 107520
    v_add_u32 v111, s23, v163
    v_xor_b32 v113, 4, v161
    s_lshl_b32 s23, s36, 12
    s_add_u32 s23, s23, 107520
    v_add_u32 v112, s23, v163
    s_lshr_b32 s38, s13, 2
    s_add_u32 s38, s38, 7
    v_add_u32 v152, s37, v152
    v_add_u32 v153, s37, v153
    v_add_u32 v154, s37, v154
    v_add_u32 v155, s37, v155
    v_add_u32 v156, s37, v156
    v_add_u32 v157, s37, v157
    v_mov_b32 v84, 0
    v_mov_b32 v85, 0
    v_mov_b32 v86, 0
    v_mov_b32 v87, 0
    v_mov_b32 v88, 0
    v_mov_b32 v89, 0
    v_mov_b32 v90, 0
    v_mov_b32 v91, 0
    v_mov_b32 v92, 0
    v_mov_b32 v93, 0
    v_mov_b32 v94, 0
    v_mov_b32 v95, 0
    v_mov_b32 v96, 0
    v_mov_b32 v97, 0
    v_mov_b32 v98, 0
    v_mov_b32 v99, 0
    v_mov_b32 v68, v160
    v_mov_b32 v69, v160
    v_mov_b32 v70, v160
    v_mov_b32 v71, v160
    v_mov_b32 v72, v160
    v_mov_b32 v73, v160
    v_mov_b32 v74, v160
    v_mov_b32 v75, v160
    v_mov_b32 v76, v160
    v_mov_b32 v77, v160
    v_mov_b32 v78, v160
    v_mov_b32 v79, v160
    v_mov_b32 v20, 0
    v_mov_b32 v21, 0
    v_mov_b32 v22, 0
    v_mov_b32 v23, 0
    v_mov_b32 v24, 0
    v_mov_b32 v25, 0
    v_mov_b32 v26, 0
    v_mov_b32 v27, 0
    v_mov_b32 v28, 0
    v_mov_b32 v29, 0
    v_mov_b32 v30, 0
    v_mov_b32 v31, 0
    v_mov_b32 v32, 0
    v_mov_b32 v33, 0
    v_mov_b32 v34, 0
    v_mov_b32 v35, 0
    v_mov_b32 v36, -1
    v_mov_b32 v37, -1
    v_mov_b32 v38, -1
    v_mov_b32 v39, -1
    v_mov_b32 v128, 0
    v_mov_b32 v129, 0
    v_mov_b32 v130, 0
    v_mov_b32 v131, 0
    v_mov_b32 v132, 0
    v_mov_b32 v133, 0
    v_mov_b32 v134, 0
    v_mov_b32 v135, 0
    v_mov_b32 v114, 0xdddddddd
    s_barrier
    s_setprio 3
    s_cmp_lg_u32 s34, 1
    s_cbranch_scc1 ATT_NOSIG
    s_cmp_eq_u32 s22, 1
    s_cbranch_scc1 NU_QK
    s_cmp_eq_u32 s22, 2
    s_cbranch_scc1 NU_V
    s_branch NU_D
ATT_SIG:
    v_mov_b32 v83, 158764
    s_and_b32 s23, s15, -128
    s_mov_b64 exec, 1
    s_waitcnt vmcnt(0)
    ds_add_rtn_u32 v83, v83, v82
    s_waitcnt lgkmcnt(0)
    v_cmp_eq_u32 vcc, 3, v83
    s_cbranch_vccz ATT_NOSIG
    buffer_store_dwordx4 v[36:39], v20, s[28:31], s23 offen sc1
ATT_NOSIG:
    s_mov_b64 exec, -1
    ds_read_b128 v[16:19], v108
    ds_read_b32 v62, v109 offset:1024
    ds_read_b128 v[100:103], v106
    ds_read_b32 v104, v107 offset:1024
    ds_read_b128 v[56:59], v80
    ds_read_b32 v60, v81 offset:1024
    s_mov_b64 exec, s[24:25]
    ds_read_b128 v[68:71], v154 offset:1280
    ds_read_b128 v[72:75], v154 offset:1920
    s_mov_b64 exec, -1
    s_waitcnt lgkmcnt(4)
    v_mfma_f32_32x32x16_bf16 v[0:15], v[16:19], v[100:103], 0
    v_mfma_f32_32x32x8_bf16 v[0:15], v[62:63], v[104:105], v[0:15]
    s_waitcnt lgkmcnt(2)
    v_mfma_f32_32x32x16_bf16 v[40:55], v[16:19], v[56:59], 0
    v_mfma_f32_32x32x8_bf16 v[40:55], v[62:63], v[60:61], v[40:55]
    ds_read_b128 v[16:19], v152 offset:0
    ds_read_b32 v62, v153 offset:1024
    s_mov_b32 s26, 0
    s_nop 5
    v_max3_f32 v80, v0, v1, v2
    v_max3_f32 v81, v3, v4, v5
    v_max3_f32 v80, v6, v7, v80
    v_max3_f32 v81, v8, v9, v81
    v_max3_f32 v80, v10, v11, v80
    v_max3_f32 v81, v12, v13, v81
    v_max3_f32 v80, v14, v15, v80
    v_max_f32 v80, v80, v81
    v_mul_f32 v80, 0xbf000000, v80
    v_cvt_pk_bf16_f32 v105, v80, 0
    s_waitcnt lgkmcnt(0)
    v_mfma_f32_32x32x16_bf16 v[0:15], v[16:19], v[100:103], 0
    v_mfma_f32_32x32x8_bf16 v[0:15], v[62:63], v[104:105], v[0:15]
    v_max3_f32 v80, v40, v41, v42
    v_max3_f32 v81, v43, v44, v45
    v_max3_f32 v80, v46, v47, v80
    v_max3_f32 v81, v48, v49, v81
    v_max3_f32 v80, v50, v51, v80
    v_max3_f32 v81, v52, v53, v81
    v_max3_f32 v80, v54, v55, v80
    v_max_f32 v80, v80, v81
    v_mul_f32 v80, 0xbf000000, v80
    v_cvt_pk_bf16_f32 v61, v80, 0
    v_mfma_f32_32x32x16_bf16 v[40:55], v[16:19], v[56:59], 0
    ds_read_b128 v[16:19], v152 offset:5120
ATT_LOOP:
    v_mfma_f32_32x32x8_bf16 v[40:55], v[62:63], v[60:61], v[40:55]
    ds_read_b32 v62, v153 offset:6144
    v_exp_f32 v0, v0
    v_exp_f32 v1, v1
    v_exp_f32 v2, v2
    v_exp_f32 v3, v3
    v_smfmac_f32_32x32x32_bf16 v[20:35], v[76:79], v[128:135], v114
    s_waitcnt lgkmcnt(1)
    v_exp_f32 v4, v4
    v_exp_f32 v5, v5
    v_exp_f32 v6, v6
    v_exp_f32 v7, v7
    v_mfma_f32_32x32x16_bf16 v[136:151], v[16:19], v[100:103], 0
    v_exp_f32 v8, v8
    v_exp_f32 v9, v9
    v_exp_f32 v10, v10
    v_exp_f32 v11, v11
    v_smfmac_f32_32x32x32_bf16 v[84:99], v[68:71], v[0:7], v114
    v_exp_f32 v12, v12
    v_exp_f32 v13, v13
    v_exp_f32 v14, v14
    v_exp_f32 v15, v15
    s_waitcnt lgkmcnt(0)
    v_mfma_f32_32x32x8_bf16 v[136:151], v[62:63], v[104:105], v[136:151]
    v_exp_f32 v40, v40
    v_exp_f32 v41, v41
    v_exp_f32 v42, v42
    v_exp_f32 v43, v43
    v_smfmac_f32_32x32x32_bf16 v[84:99], v[72:75], v[8:15], v114
    v_exp_f32 v44, v44
    v_exp_f32 v45, v45
    v_exp_f32 v46, v46
    v_exp_f32 v47, v47
    v_mfma_f32_32x32x16_bf16 v[120:135], v[16:19], v[56:59], 0
    ds_read_b128 v[16:19], v152 offset:10240
    v_exp_f32 v48, v48
    v_exp_f32 v49, v49
    v_exp_f32 v50, v50
    v_exp_f32 v51, v51
    v_smfmac_f32_32x32x32_bf16 v[20:35], v[68:71], v[40:47], v114
    s_mov_b64 exec, s[24:25]
    ds_read_b128 v[68:71], v154 offset:6400
    ds_read_b128 v[76:79], v154 offset:7040
    s_mov_b64 exec, -1
    v_exp_f32 v52, v52
    v_exp_f32 v53, v53
    v_exp_f32 v54, v54
    v_exp_f32 v55, v55
    v_mfma_f32_32x32x8_bf16 v[120:135], v[62:63], v[60:61], v[120:135]
    ds_read_b32 v62, v153 offset:11264
    v_exp_f32 v136, v136
    v_exp_f32 v137, v137
    v_exp_f32 v138, v138
    v_exp_f32 v139, v139
    v_smfmac_f32_32x32x32_bf16 v[20:35], v[72:75], v[48:55], v114
    s_waitcnt lgkmcnt(1)
    v_exp_f32 v140, v140
    v_exp_f32 v141, v141
    v_exp_f32 v142, v142
    v_exp_f32 v143, v143
    v_mfma_f32_32x32x16_bf16 v[0:15], v[16:19], v[100:103], 0
    v_exp_f32 v144, v144
    v_exp_f32 v145, v145
    v_exp_f32 v146, v146
    v_exp_f32 v147, v147
    v_smfmac_f32_32x32x32_bf16 v[84:99], v[68:71], v[136:143], v114
    v_exp_f32 v148, v148
    v_exp_f32 v149, v149
    v_exp_f32 v150, v150
    v_exp_f32 v151, v151
    s_waitcnt lgkmcnt(0)
    v_mfma_f32_32x32x8_bf16 v[0:15], v[62:63], v[104:105], v[0:15]
    v_exp_f32 v120, v120
    v_exp_f32 v121, v121
    v_exp_f32 v122, v122
    v_exp_f32 v123, v123
    v_smfmac_f32_32x32x32_bf16 v[84:99], v[76:79], v[144:151], v114
    ds_write_b32 v161, v82
    v_exp_f32 v124, v124
    v_exp_f32 v125, v125
    v_exp_f32 v126, v126
    v_exp_f32 v127, v127
    v_mfma_f32_32x32x16_bf16 v[40:55], v[16:19], v[56:59], 0
    ds_read_b128 v[16:19], v155 offset:0
    v_exp_f32 v128, v128
    v_exp_f32 v129, v129
    v_exp_f32 v130, v130
    v_exp_f32 v131, v131
    v_smfmac_f32_32x32x32_bf16 v[20:35], v[68:71], v[120:127], v114
    s_mov_b64 exec, s[24:25]
    ds_read_b128 v[68:71], v154 offset:11520
    ds_read_b128 v[72:75], v154 offset:12160
    s_mov_b64 exec, -1
    v_exp_f32 v132, v132
    v_exp_f32 v133, v133
    v_exp_f32 v134, v134
    v_exp_f32 v135, v135
    v_mfma_f32_32x32x8_bf16 v[40:55], v[62:63], v[60:61], v[40:55]
    ds_read_b32 v62, v156 offset:1024
    v_exp_f32 v0, v0
    v_exp_f32 v1, v1
    v_exp_f32 v2, v2
    v_exp_f32 v3, v3
    v_smfmac_f32_32x32x32_bf16 v[20:35], v[76:79], v[128:135], v114
    s_waitcnt lgkmcnt(1)
    v_exp_f32 v4, v4
    v_exp_f32 v5, v5
    v_exp_f32 v6, v6
    v_exp_f32 v7, v7
    v_mfma_f32_32x32x16_bf16 v[136:151], v[16:19], v[100:103], 0
    v_exp_f32 v8, v8
    v_exp_f32 v9, v9
    v_exp_f32 v10, v10
    v_exp_f32 v11, v11
    v_smfmac_f32_32x32x32_bf16 v[84:99], v[68:71], v[0:7], v114
    v_exp_f32 v12, v12
    v_exp_f32 v13, v13
    v_exp_f32 v14, v14
    v_exp_f32 v15, v15
    s_waitcnt lgkmcnt(0)
    v_mfma_f32_32x32x8_bf16 v[136:151], v[62:63], v[104:105], v[136:151]
    v_exp_f32 v40, v40
    v_exp_f32 v41, v41
    v_exp_f32 v42, v42
    v_exp_f32 v43, v43
    v_smfmac_f32_32x32x32_bf16 v[84:99], v[72:75], v[8:15], v114
    v_exp_f32 v44, v44
    v_exp_f32 v45, v45
    v_exp_f32 v46, v46
    v_exp_f32 v47, v47
    v_mfma_f32_32x32x16_bf16 v[120:135], v[16:19], v[56:59], 0
    ds_read_b128 v[16:19], v152 offset:20480
    v_exp_f32 v48, v48
    v_exp_f32 v49, v49
    v_exp_f32 v50, v50
    v_exp_f32 v51, v51
    v_smfmac_f32_32x32x32_bf16 v[20:35], v[68:71], v[40:47], v114
    s_mov_b64 exec, s[24:25]
    ds_read_b128 v[68:71], v157 offset:1280
    ds_read_b128 v[76:79], v157 offset:1920
    s_mov_b64 exec, -1
    v_exp_f32 v52, v52
    v_exp_f32 v53, v53
    v_exp_f32 v54, v54
    v_exp_f32 v55, v55
    v_mfma_f32_32x32x8_bf16 v[120:135], v[62:63], v[60:61], v[120:135]
    ds_read_b32 v62, v153 offset:21504
    v_exp_f32 v136, v136
    v_exp_f32 v137, v137
    v_exp_f32 v138, v138
    v_exp_f32 v139, v139
    v_smfmac_f32_32x32x32_bf16 v[20:35], v[72:75], v[48:55], v114
    s_waitcnt vmcnt(0) lgkmcnt(1)
    v_exp_f32 v140, v140
    v_exp_f32 v141, v141
    v_exp_f32 v142, v142
    v_exp_f32 v143, v143
    v_mfma_f32_32x32x16_bf16 v[0:15], v[16:19], v[100:103], 0
    v_exp_f32 v144, v144
    v_exp_f32 v145, v145
    v_exp_f32 v146, v146
    v_exp_f32 v147, v147
    v_smfmac_f32_32x32x32_bf16 v[84:99], v[68:71], v[136:143], v114
    v_exp_f32 v148, v148
    v_exp_f32 v149, v149
    v_exp_f32 v150, v150
    v_exp_f32 v151, v151
    s_waitcnt lgkmcnt(0)
    v_mfma_f32_32x32x8_bf16 v[0:15], v[62:63], v[104:105], v[0:15]
    v_exp_f32 v120, v120
    v_exp_f32 v121, v121
    v_exp_f32 v122, v122
    v_exp_f32 v123, v123
    v_smfmac_f32_32x32x32_bf16 v[84:99], v[76:79], v[144:151], v114
    ds_read_b32 v106, v110
    v_exp_f32 v124, v124
    v_exp_f32 v125, v125
    v_exp_f32 v126, v126
    v_exp_f32 v127, v127
    v_mfma_f32_32x32x16_bf16 v[40:55], v[16:19], v[56:59], 0
    ds_read_b128 v[16:19], v152 offset:25600
    v_exp_f32 v128, v128
    v_exp_f32 v129, v129
    v_exp_f32 v130, v130
    v_exp_f32 v131, v131
    v_smfmac_f32_32x32x32_bf16 v[20:35], v[68:71], v[120:127], v114
    s_mov_b64 exec, s[24:25]
    ds_read_b128 v[68:71], v154 offset:21760
    ds_read_b128 v[72:75], v154 offset:22400
    s_mov_b64 exec, -1
    v_exp_f32 v132, v132
    v_exp_f32 v133, v133
    v_exp_f32 v134, v134
    v_exp_f32 v135, v135
    s_add_u32 s26, s26, 1
    s_movk_i32 s27, 0x5000
    s_cmp_eq_u32 s26, 7
    s_cselect_b32 s27, 4294829056, s27
    v_add_u32 v152, 0x5000, v152
    v_add_u32 v153, 0x5000, v153
    v_add_u32 v154, 0x5000, v154
    v_add_u32 v155, s27, v155
    v_add_u32 v156, s27, v156
    v_add_u32 v157, s27, v157
    v_add_u32 v82, 1, v82
    s_bitcmp1_b32 s35, s26
    s_cbranch_scc0 ATT_LOOP
    s_cmp_gt_u32 s26, 3
    s_cbranch_scc1 ATT_EV
    v_add_u32 v162, 8, v162
    s_cmp_eq_u32 s26, 1
    s_cbranch_scc0 ATT_WAIT
    buffer_store_dwordx4 v[36:39], v158, s[28:31], s6 offen sc1
    s_mov_b64 exec, 0xffff
    buffer_store_dwordx4 v[36:39], v159, s[28:31], s7 offen sc1
    s_mov_b64 exec, -1
ATT_WAIT:
    ds_read_b32 v80, v162
    s_waitcnt lgkmcnt(0)
    v_readfirstlane_b32 s23, v80
    s_cmp_ge_u32 s23, 4
    s_cbranch_scc1 ATT_LOOP
    s_sleep 1
    s_branch ATT_WAIT
ATT_EV:
    s_setprio 2
    s_cmp_eq_u32 s26, s40
    s_cbranch_scc1 ATT_LOOP
    s_setprio 1
    s_cmp_lt_u32 s26, 8
    s_cbranch_scc1 ATT_LOOP
    s_setprio 3
    v_smfmac_f32_32x32x32_bf16 v[20:35], v[76:79], v[128:135], v114
    s_mov_b32 s27, 0x3e800000
    s_mov_b32 s23, 0x71800000
    s_waitcnt lgkmcnt(3)
    v_cmp_gt_u32 vcc, s38, v106
    s_cbranch_vccz ATT_X0
ATT_X1:
    s_sleep 2
    ds_read_b32 v106, v110
    s_waitcnt lgkmcnt(0)
    v_cmp_gt_u32 vcc, s38, v106
    s_cbranch_vccnz ATT_X1
ATT_X0:
    ds_write_b128 v111, v[84:87] offset:0
    ds_write_b128 v111, v[88:91] offset:1024
    ds_write_b128 v111, v[92:95] offset:2048
    ds_write_b32 v161, v82 offset:96
ATT_X2:
    ds_read_b32 v106, v113 offset:96
    ds_read_b128 v[0:3], v112 offset:0
    ds_read_b128 v[4:7], v112 offset:1024
    ds_read_b128 v[8:11], v112 offset:2048
    s_waitcnt lgkmcnt(0)
    v_cmp_eq_u32 vcc, 0, v106
    s_cbranch_vccz ATT_X3
    s_sleep 1
    s_branch ATT_X2
ATT_X3:
    s_nop 3
    v_add_f32 v32, v28, v8
    v_add_f32 v33, v28, v8
    v_pk_add_f32 v[20:21], v[20:21], v[0:1]
    v_pk_add_f32 v[22:23], v[22:23], v[2:3]
    v_pk_add_f32 v[24:25], v[24:25], v[4:5]
    v_pk_add_f32 v[26:27], v[26:27], v[6:7]
    v_pk_add_f32 v[28:29], v[28:29], v[8:9]
    v_pk_add_f32 v[30:31], v[30:31], v[10:11]
    v_permlane32_swap_b32 v33, v32
    s_nop 0
    v_rcp_f32 v82, v32
    v_add_f32 v80, |v20|, |v21|
    v_add_f32 v81, |v22|, |v23|
    v_add_f32 v80, |v24|, v80
    v_add_f32 v81, |v25|, v81
    v_add_f32 v80, |v26|, v80
    v_add_f32 v81, |v27|, v81
    v_add_f32 v80, |v28|, v80
    v_add_f32 v81, |v29|, v81
    v_add_f32 v80, |v30|, v80
    v_add_f32 v81, |v31|, v81
    v_add_f32 v80, v80, v32
    v_cmp_le_f32 s[42:43], s27, v32
    v_add_f32 v80, v80, v81
    v_cmp_gt_f32 vcc, s23, v80
    s_and_b64 vcc, vcc, s[42:43]
    s_cmp_eq_u64 vcc, -1
    s_cbranch_scc0 ATT_FALLBACK
ATT_FINISH:
    v_pk_mul_f32 v[20:21], v[20:21], v[82:83] op_sel_hi:[1,0]
    v_pk_mul_f32 v[22:23], v[22:23], v[82:83] op_sel_hi:[1,0]
    v_pk_mul_f32 v[24:25], v[24:25], v[82:83] op_sel_hi:[1,0]
    v_pk_mul_f32 v[26:27], v[26:27], v[82:83] op_sel_hi:[1,0]
    v_cvt_pk_bf16_f32 v36, v20, v21
    v_cvt_pk_bf16_f32 v37, v22, v23
    v_cvt_pk_bf16_f32 v38, v24, v25
    v_cvt_pk_bf16_f32 v39, v26, v27
    v_min_u32 v36, -2, v36
    v_min_u32 v37, -2, v37
    v_min_u32 v38, -2, v38
    v_min_u32 v39, -2, v39
    buffer_store_dwordx4 v[36:39], v158, s[28:31], s6 offen sc1
    v_pk_mul_f32 v[28:29], v[28:29], v[82:83] op_sel_hi:[1,0]
    v_pk_mul_f32 v[30:31], v[30:31], v[82:83] op_sel_hi:[1,0]
    v_cvt_pk_bf16_f32 v64, v28, v29
    v_cvt_pk_bf16_f32 v65, v30, v31
    v_min_u32 v64, -2, v64
    v_min_u32 v65, -2, v65
    s_nop 1
    v_permlane16_swap_b32 v64, v66
    v_permlane16_swap_b32 v65, v67
    s_mov_b64 exec, 0xffff
    buffer_store_dwordx4 v[64:67], v159, s[28:31], s7 offen sc1
    s_cmp_ge_u32 s13, 4
    s_cbranch_scc1 L_END
    s_mov_b64 exec, -1
    s_xor_b32 s41, s13, 2
    s_mov_b32 s47, 1
    s_branch P3_GO
ATT_FALLBACK:
    s_waitcnt lgkmcnt(0)
    v_mov_b32 v61, 0
    v_mov_b32 v80, 0xff800000
    s_add_u32 s23, s37, 163840
    v_subrev_u32 v152, s23, v152
    v_subrev_u32 v153, s23, v153
    v_subrev_u32 v154, s23, v154
    s_add_u32 s23, s14, 0
    s_mov_b32 s26, 0
ATT_FB1:
    buffer_load_dwordx4 v[16:19], v152, s[28:31], s23 offen sc1
    buffer_load_dword v62, v153, s[28:31], s23 offen offset:1024 sc1
    s_add_u32 s23, s23, 2560
    s_waitcnt vmcnt(0)
    v_mfma_f32_32x32x16_bf16 v[0:15], v[16:19], v[56:59], 0
    v_mfma_f32_32x32x8_bf16 v[0:15], v[62:63], v[60:61], v[0:15]
    s_nop 15
    v_max3_f32 v80, v0, v1, v80
    v_max3_f32 v80, v2, v3, v80
    v_max3_f32 v80, v4, v5, v80
    v_max3_f32 v80, v6, v7, v80
    v_max3_f32 v80, v8, v9, v80
    v_max3_f32 v80, v10, v11, v80
    v_max3_f32 v80, v12, v13, v80
    v_max3_f32 v80, v14, v15, v80
    s_add_u32 s26, s26, 1
    s_cmp_lt_u32 s26, 64
    s_cbranch_scc1 ATT_FB1
    v_mov_b32 v81, v80
    s_nop 1
    v_permlane32_swap_b32 v80, v81
    s_nop 0
    v_max_f32 v80, v80, v81
    s_add_u32 s23, s14, 0
    s_mov_b32 s26, 0
    v_mov_b32 v20, 0
    v_mov_b32 v21, 0
    v_mov_b32 v22, 0
    v_mov_b32 v23, 0
    v_mov_b32 v24, 0
    v_mov_b32 v25, 0
    v_mov_b32 v26, 0
    v_mov_b32 v27, 0
    v_mov_b32 v28, 0
    v_mov_b32 v29, 0
    v_mov_b32 v30, 0
    v_mov_b32 v31, 0
    v_mov_b32 v32, 0
    v_mov_b32 v33, 0
    v_mov_b32 v34, 0
    v_mov_b32 v35, 0
ATT_FB2:
    buffer_load_dwordx4 v[16:19], v152, s[28:31], s23 offen sc1
    buffer_load_dword v62, v153, s[28:31], s23 offen offset:1024 sc1
    s_mov_b64 exec, s[24:25]
    buffer_load_dwordx4 v[68:71], v154, s[28:31], s23 offen offset:1280 sc1
    buffer_load_dwordx4 v[72:75], v154, s[28:31], s23 offen offset:1920 sc1
    s_mov_b64 exec, -1
    s_add_u32 s23, s23, 2560
    s_waitcnt vmcnt(0)
    v_mfma_f32_32x32x16_bf16 v[0:15], v[16:19], v[56:59], 0
    v_mfma_f32_32x32x8_bf16 v[0:15], v[62:63], v[60:61], v[0:15]
    s_nop 15
    v_sub_f32 v0, v0, v80
    v_sub_f32 v1, v1, v80
    v_sub_f32 v2, v2, v80
    v_sub_f32 v3, v3, v80
    v_sub_f32 v4, v4, v80
    v_sub_f32 v5, v5, v80
    v_sub_f32 v6, v6, v80
    v_sub_f32 v7, v7, v80
    v_sub_f32 v8, v8, v80
    v_sub_f32 v9, v9, v80
    v_sub_f32 v10, v10, v80
    v_sub_f32 v11, v11, v80
    v_sub_f32 v12, v12, v80
    v_sub_f32 v13, v13, v80
    v_sub_f32 v14, v14, v80
    v_sub_f32 v15, v15, v80
    v_exp_f32 v0, v0
    v_exp_f32 v1, v1
    v_exp_f32 v2, v2
    v_exp_f32 v3, v3
    v_exp_f32 v4, v4
    v_exp_f32 v5, v5
    v_exp_f32 v6, v6
    v_exp_f32 v7, v7
    v_exp_f32 v8, v8
    v_exp_f32 v9, v9
    v_exp_f32 v10, v10
    v_exp_f32 v11, v11
    v_exp_f32 v12, v12
    v_exp_f32 v13, v13
    v_exp_f32 v14, v14
    v_exp_f32 v15, v15
    s_nop 1
    v_smfmac_f32_32x32x32_bf16 v[20:35], v[68:71], v[0:7], v114
    v_smfmac_f32_32x32x32_bf16 v[20:35], v[72:75], v[8:15], v114
    s_add_u32 s26, s26, 1
    s_cmp_lt_u32 s26, 64
    s_cbranch_scc1 ATT_FB2
    s_nop 15
    s_nop 3
    v_mov_b32 v32, v28
    v_mov_b32 v33, v28
    s_nop 1
    v_permlane32_swap_b32 v33, v32
    s_nop 0
    v_rcp_f32 v82, v32
    s_nop 0
    s_branch ATT_FINISH
HELPER:
    s_mov_b32 s61, s22
    s_mov_b32 s28, s58
    s_mov_b32 s29, s59
    s_mov_b32 s30, 15577088
    s_mov_b32 s31, 0x20000
    s_setprio 0
    s_lshr_b32 s20, s18, 2
    s_mul_i32 s26, s20, 160
    s_movk_i32 s23, 1120
    v_add_u32 v132, 0, v0
    v_mul_u32_u24 v133, 6554, v132
    v_lshrrev_b32 v133, 16, v133
    v_lshlrev_b32 v132, 4, v132
    v_mad_u32_u24 v112, v133, s23, v132
    v_add_u32 v132, 64, v0
    v_mul_u32_u24 v133, 6554, v132
    v_lshrrev_b32 v133, 16, v133
    v_lshlrev_b32 v132, 4, v132
    v_mad_u32_u24 v113, v133, s23, v132
    v_add_u32 v132, 128, v0
    v_mul_u32_u24 v133, 6554, v132
    v_lshrrev_b32 v133, 16, v133
    v_lshlrev_b32 v132, 4, v132
    v_mad_u32_u24 v114, v133, s23, v132
    v_add_u32 v132, 192, v0
    v_mul_u32_u24 v133, 6554, v132
    v_lshrrev_b32 v133, 16, v133
    v_lshlrev_b32 v132, 4, v132
    v_mad_u32_u24 v115, v133, s23, v132
    v_add_u32 v132, 256, v0
    v_mul_u32_u24 v133, 6554, v132
    v_lshrrev_b32 v133, 16, v133
    v_lshlrev_b32 v132, 4, v132
    v_mad_u32_u24 v116, v133, s23, v132
    s_lshl_b32 s21, s17, 3
    s_and_b32 s22, s18, 3
    s_add_u32 s21, s21, s22
    s_lshr_b32 s22, s16, 1
    s_lshl_b32 s22, s22, 2
    s_add_u32 s21, s21, s22
    s_lshl_b32 s21, s21, 1
    s_and_b32 s22, s16, 1
    s_add_u32 s21, s21, s22
    s_lshr_b32 s22, s21, 2
    s_lshl_b32 s22, s22, 1
    s_and_b32 s24, s21, 1
    s_add_u32 s22, s22, s24
    s_lshl_b32 s22, s22, 3
    v_and_b32 v132, 7, v0
    v_add_u32 v132, s22, v132
    s_bitcmp1_b32 s21, 1
    s_cselect_b32 s22, 0x400, 0
    s_cselect_b32 s24, -1, 1
    v_mul_lo_u32 v133, v132, s24
    s_sub_u32 s24, 0x800, s22
    v_sub_u32 v134, s24, v133
    v_add_u32 v133, s22, v133
    v_and_b32 v135, 8, v0
    v_cmp_ne_u32 vcc, 0, v135
    v_cmp_eq_u32 s[42:43], 0, v132
    v_lshlrev_b32 v135, 6, v135
    v_add_u32 v135, s22, v135
    v_cndmask_b32 v132, v133, v134, vcc
    v_lshrrev_b32 v133, 4, v0
    v_cndmask_b32 v132, v132, v135, s[42:43]
    v_mul_u32_u24 v162, 1280, v132
    v_mul_u32_u24 v134, 40, v133
    v_add3_u32 v162, v162, v134, s26
    v_lshlrev_b32 v117, 2, v132
    v_sub_u32 v135, 0x800, v132
    v_cmp_lt_u32 vcc, 0x400, v132
    v_min_u32 v132, v132, v135
    v_and_b32 v135, 1, v132
    v_mul_u32_u24 v118, 8704, v135
    v_lshrrev_b32 v135, 1, v132
    v_lshl_add_u32 v118, v135, 4, v118
    v_mov_b32 v135, 0x02020202
    v_cndmask_b32 v119, 0, v135, vcc
    s_cmp_ge_u32 s20, 4
    s_mov_b32 s24, 0x05040100
    s_cselect_b32 s24, 0x07060302, s24
    s_cselect_b32 s40, -1, 1
    s_cselect_b32 s41, 155, 0
    v_xor_b32 v119, s24, v119
    s_mul_i32 s24, s20, 20
    v_mul_u32_u24 v135, 5, v133
    v_add_u32 v135, s24, v135
    v_mul_lo_u32 v135, v135, s40
    v_add_u32 v135, s41, v135
    v_mul_u32_u24 v135, 17408, v135
    v_add_u32 v118, v118, v135
    v_lshlrev_b32 v163, 4, v0
    v_and_b32 v2, 7, v0
    v_bfe_u32 v4, v0, 3, 1
    v_lshrrev_b32 v3, 4, v0
    v_lshlrev_b32 v164, 8, v3
    v_lshl_add_u32 v164, v2, 4, v164
    v_lshl_add_u32 v164, v4, 3, v164
    v_bfe_u32 v2, v0, 2, 2
    v_and_b32 v5, 3, v0
    v_mul_u32_u24 v5, 40, v5
    v_mul_u32_u24 v4, 40, v3
    v_add3_u32 v4, v4, v2, 16
    v_mul_u32_u24 v4, 160, v4
    v_add_u32 v166, v4, v5
    v_lshrrev_b32 v4, 1, v3
    v_mul_u32_u24 v4, 20, v4
    v_and_b32 v3, 1, v3
    v_lshl_add_u32 v4, v3, 2, v4
    v_add_u32 v4, v4, v2
    v_mul_u32_u24 v4, 160, v4
    v_add_u32 v165, v4, v5
    v_lshlrev_b32 v120, 2, v0
    v_add_u32 v120, 158720, v120
    v_mov_b32 v121, 1
    s_and_b32 s23, s2, 63
    s_lshl_b32 s23, s23, 5
    s_lshr_b32 s24, s2, 6
    s_add_u32 s23, s23, s24
    s_lshl_b32 s23, s23, 2
    s_add_u32 s23, s23, 15568896
    v_mov_b32 v122, s23
    v_lshrrev_b32 v133, 5, v0
    v_mul_u32_u24 v123, 17408, v133
    v_and_b32 v132, 31, v0
    v_lshl_add_u32 v123, v132, 4, v123
    v_lshlrev_b32 v124, 31, v0
    v_lshlrev_b32 v125, 4, v133
    v_and_b32 v132, 15, v0
    v_lshlrev_b32 v132, 4, v132
    v_lshl_add_u32 v132, v133, 8, v132
    v_bfe_u32 v133, v0, 4, 1
    v_lshl_add_u32 v128, v133, 14, v132
    v_lshl_add_u32 v129, v133, 11, v132
    v_lshlrev_b32 v126, 7, v0
    v_bfe_u32 v127, v0, 1, 2
    v_lshlrev_b32 v127, 13, v127
    v_and_b32 v132, 1, v0
    v_lshl_add_u32 v127, v132, 7, v127
    s_setprio 3
    s_lshr_b32 s19, s18, 3
    s_lshl_b32 s23, s17, 2
    s_add_u32 s19, s19, s23
    s_and_b32 s62, s18, 7
    s_mul_i32 s21, s19, 164352
    v_lshlrev_b32 v1, 4, v0
    s_lshr_b32 s23, s19, 3
    s_lshl_b32 s23, s23, 13
    s_add_u32 s23, s23, 15536128
    v_lshlrev_b32 v2, 7, v0
    v_add_u32 v2, s23, v2
    s_add_u32 s24, s21, 0
    s_lshl_b32 s40, 0x10000, s16
    s_lshl_b32 s41, 1, s16
    s_mul_i32 s22, s16, 10240
    s_add_u32 s26, s24, s22
    s_cmp_lg_u32 s16, 3
    s_cbranch_scc1 H_JA
    s_lshl_b32 s25, s62, 1
    s_lshl_b32 s40, 3, s25
    s_mov_b32 s41, 0
    s_mov_b32 s22, 71680
    s_mul_i32 s26, s19, 82432
    s_mul_i32 s25, s62, 10240
    s_add_u32 s26, s26, s25
    s_add_u32 s26, s26, 5259264
H_JA:
    s_mul_i32 s23, s12, 12
    s_cmp_eq_u32 s61, 3
    s_cselect_b32 s23, 12, s23
    s_add_u32 s23, s23, 158764
    v_mov_b32 v3, s23
    s_mov_b64 exec, 1
    s_branch L_LWE2
L_LW2:
    s_sleep 2
L_LWE2:
    ds_read_b32 v4, v3
    s_waitcnt lgkmcnt(0)
    v_cmp_gt_u32 vcc, 4, v4
    s_cbranch_vccnz L_LW2
    s_mov_b64 exec, -1
    s_mov_b64 exec, s[40:41]
    s_mov_b32 s60, 0
    s_branch L_POLLE3
L_POLL3:
    s_sleep 2
L_POLLE3:
    buffer_load_dwordx4 v[4:7], v2, s[28:31], 0 offen sc1
    s_add_u32 s60, s60, 1
    s_waitcnt vmcnt(0)
    v_min3_u32 v4, v4, v5, v6
    s_cmp_lt_u32 s60, 0x40000
    v_min_u32 v4, v4, v7
    s_cbranch_scc0 L_POLLD3
    v_cmp_eq_u32 vcc, 0, v4
    s_cbranch_vccnz L_POLL3
L_POLLD3:
    s_mov_b64 exec, -1
    s_add_u32 s25, s22, 5120
    s_cmp_ge_u32 s25, 158720
    s_cselect_b32 s25, 0, s25
    s_add_u32 m0, s22, 0
    s_add_u32 s27, s26, 0
    buffer_load_dwordx4 v1, s[28:31], s27 offen offset:0 sc1 lds
    buffer_load_dwordx4 v1, s[28:31], s27 offen offset:1024 sc1 lds
    buffer_load_dwordx4 v1, s[28:31], s27 offen offset:2048 sc1 lds
    s_add_u32 m0, s22, 3072
    s_add_u32 s27, s26, 3072
    buffer_load_dwordx4 v1, s[28:31], s27 offen offset:0 sc1 lds
    buffer_load_dwordx4 v1, s[28:31], s27 offen offset:1024 sc1 lds
    s_add_u32 m0, s25, 0
    s_add_u32 s27, s26, 5120
    buffer_load_dwordx4 v1, s[28:31], s27 offen offset:0 sc1 lds
    buffer_load_dwordx4 v1, s[28:31], s27 offen offset:1024 sc1 lds
    buffer_load_dwordx4 v1, s[28:31], s27 offen offset:2048 sc1 lds
    s_add_u32 m0, s25, 3072
    s_add_u32 s27, s26, 8192
    buffer_load_dwordx4 v1, s[28:31], s27 offen offset:0 sc1 lds
    buffer_load_dwordx4 v1, s[28:31], s27 offen offset:1024 sc1 lds
    s_lshl_b32 s40, 0x80000, s16
    s_lshl_b32 s41, 8, s16
    s_add_u32 s22, s16, 3
    s_mul_i32 s22, s22, 10240
    s_add_u32 s26, s24, s22
    s_waitcnt vmcnt(0)
    s_barrier
    s_mov_b64 exec, s[40:41]
    s_mov_b32 s60, 0
    s_branch L_POLLE4
L_POLL4:
    s_sleep 2
L_POLLE4:
    buffer_load_dwordx4 v[4:7], v2, s[28:31], 0 offen sc1
    s_add_u32 s60, s60, 1
    s_waitcnt vmcnt(0)
    v_min3_u32 v4, v4, v5, v6
    s_cmp_lt_u32 s60, 0x40000
    v_min_u32 v4, v4, v7
    s_cbranch_scc0 L_POLLD4
    v_cmp_eq_u32 vcc, 0, v4
    s_cbranch_vccnz L_POLL4
L_POLLD4:
    s_mov_b64 exec, -1
    s_add_u32 s25, s22, 5120
    s_cmp_ge_u32 s25, 158720
    s_cselect_b32 s25, 0, s25
    s_add_u32 m0, s22, 0
    s_add_u32 s27, s26, 0
    buffer_load_dwordx4 v1, s[28:31], s27 offen offset:0 sc1 lds
    buffer_load_dwordx4 v1, s[28:31], s27 offen offset:1024 sc1 lds
    buffer_load_dwordx4 v1, s[28:31], s27 offen offset:2048 sc1 lds
    s_add_u32 m0, s22, 3072
    s_add_u32 s27, s26, 3072
    buffer_load_dwordx4 v1, s[28:31], s27 offen offset:0 sc1 lds
    buffer_load_dwordx4 v1, s[28:31], s27 offen offset:1024 sc1 lds
    s_add_u32 m0, s25, 0
    s_add_u32 s27, s26, 5120
    buffer_load_dwordx4 v1, s[28:31], s27 offen offset:0 sc1 lds
    buffer_load_dwordx4 v1, s[28:31], s27 offen offset:1024 sc1 lds
    buffer_load_dwordx4 v1, s[28:31], s27 offen offset:2048 sc1 lds
    s_add_u32 m0, s25, 3072
    s_add_u32 s27, s26, 8192
    buffer_load_dwordx4 v1, s[28:31], s27 offen offset:0 sc1 lds
    buffer_load_dwordx4 v1, s[28:31], s27 offen offset:1024 sc1 lds
H_JB:
    s_lshl_b32 s41, 0x8880, s16
    s_and_b32 s41, s41, 0xffff
    s_lshl_b32 s40, s41, 16
    s_add_u32 s22, s16, 7
    s_mul_i32 s22, s22, 10240
    s_add_u32 s26, s24, s22
    s_waitcnt vmcnt(0)
    s_mov_b64 exec, 1
    ds_add_u32 v120, v121 offset:64
    s_mov_b64 exec, -1
    s_cmp_lg_u32 s16, 0
    s_cbranch_scc1 H_NW
    s_mov_b64 exec, 255
    s_branch L_LWE5
L_LW5:
    s_sleep 8
L_LWE5:
    ds_read_b32 v4, v120
    s_waitcnt lgkmcnt(0)
    v_cmp_gt_u32 vcc, 1, v4
    s_cbranch_vccnz L_LW5
    s_mov_b64 exec, -1
H_NW:
    s_mov_b64 exec, s[40:41]
    s_mov_b32 s60, 0
    s_branch L_POLLE6
L_POLL6:
    s_sleep 8
L_POLLE6:
    buffer_load_dwordx4 v[4:7], v2, s[28:31], 0 offen sc1
    s_add_u32 s60, s60, 1
    s_waitcnt vmcnt(0)
    v_min3_u32 v4, v4, v5, v6
    s_cmp_lt_u32 s60, 0x40000
    v_min_u32 v4, v4, v7
    s_cbranch_scc0 L_POLLD6
    v_cmp_eq_u32 vcc, 0, v4
    s_cbranch_vccnz L_POLL6
L_POLLD6:
    s_mov_b64 exec, -1
H_JC:
    s_add_u32 s25, s22, 5120
    s_cmp_ge_u32 s25, 158720
    s_cselect_b32 s25, 0, s25
    s_add_u32 m0, s22, 0
    s_add_u32 s27, s26, 0
    buffer_load_dwordx4 v1, s[28:31], s27 offen offset:0 sc1 lds
    buffer_load_dwordx4 v1, s[28:31], s27 offen offset:1024 sc1 lds
    buffer_load_dwordx4 v1, s[28:31], s27 offen offset:2048 sc1 lds
    s_add_u32 m0, s22, 3072
    s_add_u32 s27, s26, 3072
    buffer_load_dwordx4 v1, s[28:31], s27 offen offset:0 sc1 lds
    buffer_load_dwordx4 v1, s[28:31], s27 offen offset:1024 sc1 lds
    s_add_u32 m0, s25, 0
    s_add_u32 s27, s26, 5120
    buffer_load_dwordx4 v1, s[28:31], s27 offen offset:0 sc1 lds
    buffer_load_dwordx4 v1, s[28:31], s27 offen offset:1024 sc1 lds
    buffer_load_dwordx4 v1, s[28:31], s27 offen offset:2048 sc1 lds
    s_add_u32 m0, s25, 3072
    s_add_u32 s27, s26, 8192
    buffer_load_dwordx4 v1, s[28:31], s27 offen offset:0 sc1 lds
    buffer_load_dwordx4 v1, s[28:31], s27 offen offset:1024 sc1 lds
    s_add_u32 s22, s22, 40960
    s_add_u32 s26, s26, 40960
    s_cmp_lt_u32 s22, 163840
    s_cbranch_scc1 H_JC
    s_waitcnt vmcnt(0)
    s_mov_b64 exec, 1
    ds_add_u32 v120, v121 offset:72
    s_mov_b64 exec, -1
    s_lshr_b32 s22, s16, 1
    s_lshl_b32 s22, s22, 5
    s_add_u32 s22, s22, s18
    s_and_b32 s39, s16, 1
    s_cmp_lt_u32 s22, 48
    s_cbranch_scc1 H_FNET
    s_sub_u32 s24, s22, 48
    s_lshl_b32 s24, s24, 1
    s_add_u32 s24, s24, s39
    s_lshl_b32 s25, s17, 5
    s_add_u32 s24, s24, s25
    s_mov_b32 s32, s4
    s_mov_b32 s33, s5
    s_mov_b32 s34, 2621440
    s_mov_b32 s35, 0x20000
    s_mov_b32 s36, s52
    s_mov_b32 s37, s53
    s_mov_b32 s38, 1280
    s_mov_b32 s39, 0x20000
    v_lshrrev_b32 v2, 3, v0
    v_and_b32 v3, 7, v0
    v_lshlrev_b32 v3, 4, v3
    s_movk_i32 s22, 1280
    v_mad_u32_u24 v4, v2, s22, v3
    s_mul_i32 s23, s24, 10240
    buffer_load_dwordx4 v[24:27], v4, s[32:35], s23 offen offset:0
    buffer_load_dwordx4 v[28:31], v3, s[36:39], 0 offen offset:0
    buffer_load_dwordx4 v[32:35], v4, s[32:35], s23 offen offset:128
    buffer_load_dwordx4 v[36:39], v3, s[36:39], 0 offen offset:128
    buffer_load_dwordx4 v[40:43], v4, s[32:35], s23 offen offset:256
    buffer_load_dwordx4 v[44:47], v3, s[36:39], 0 offen offset:256
    buffer_load_dwordx4 v[48:51], v4, s[32:35], s23 offen offset:384
    buffer_load_dwordx4 v[52:55], v3, s[36:39], 0 offen offset:384
    buffer_load_dwordx4 v[56:59], v4, s[32:35], s23 offen offset:512
    buffer_load_dwordx4 v[60:63], v3, s[36:39], 0 offen offset:512
    buffer_load_dwordx4 v[64:67], v4, s[32:35], s23 offen offset:640
    buffer_load_dwordx4 v[68:71], v3, s[36:39], 0 offen offset:640
    buffer_load_dwordx4 v[72:75], v4, s[32:35], s23 offen offset:768
    buffer_load_dwordx4 v[76:79], v3, s[36:39], 0 offen offset:768
    buffer_load_dwordx4 v[80:83], v4, s[32:35], s23 offen offset:896
    buffer_load_dwordx4 v[84:87], v3, s[36:39], 0 offen offset:896
    buffer_load_dwordx4 v[88:91], v4, s[32:35], s23 offen offset:1024
    buffer_load_dwordx4 v[92:95], v3, s[36:39], 0 offen offset:1024
    buffer_load_dwordx4 v[96:99], v4, s[32:35], s23 offen offset:1152
    buffer_load_dwordx4 v[100:103], v3, s[36:39], 0 offen offset:1152
    v_mov_b32 v5, 0
    v_mov_b32 v6, 0
    s_waitcnt vmcnt(0)
    v_dot2c_f32_bf16 v5, v24, v28
    v_dot2c_f32_bf16 v6, v25, v29
    v_dot2c_f32_bf16 v5, v26, v30
    v_dot2c_f32_bf16 v6, v27, v31
    v_dot2c_f32_bf16 v5, v32, v36
    v_dot2c_f32_bf16 v6, v33, v37
    v_dot2c_f32_bf16 v5, v34, v38
    v_dot2c_f32_bf16 v6, v35, v39
    v_dot2c_f32_bf16 v5, v40, v44
    v_dot2c_f32_bf16 v6, v41, v45
    v_dot2c_f32_bf16 v5, v42, v46
    v_dot2c_f32_bf16 v6, v43, v47
    v_dot2c_f32_bf16 v5, v48, v52
    v_dot2c_f32_bf16 v6, v49, v53
    v_dot2c_f32_bf16 v5, v50, v54
    v_dot2c_f32_bf16 v6, v51, v55
    v_dot2c_f32_bf16 v5, v56, v60
    v_dot2c_f32_bf16 v6, v57, v61
    v_dot2c_f32_bf16 v5, v58, v62
    v_dot2c_f32_bf16 v6, v59, v63
    v_dot2c_f32_bf16 v5, v64, v68
    v_dot2c_f32_bf16 v6, v65, v69
    v_dot2c_f32_bf16 v5, v66, v70
    v_dot2c_f32_bf16 v6, v67, v71
    v_dot2c_f32_bf16 v5, v72, v76
    v_dot2c_f32_bf16 v6, v73, v77
    v_dot2c_f32_bf16 v5, v74, v78
    v_dot2c_f32_bf16 v6, v75, v79
    v_dot2c_f32_bf16 v5, v80, v84
    v_dot2c_f32_bf16 v6, v81, v85
    v_dot2c_f32_bf16 v5, v82, v86
    v_dot2c_f32_bf16 v6, v83, v87
    v_dot2c_f32_bf16 v5, v88, v92
    v_dot2c_f32_bf16 v6, v89, v93
    v_dot2c_f32_bf16 v5, v90, v94
    v_dot2c_f32_bf16 v6, v91, v95
    v_dot2c_f32_bf16 v5, v96, v100
    v_dot2c_f32_bf16 v6, v97, v101
    v_dot2c_f32_bf16 v5, v98, v102
    v_dot2c_f32_bf16 v6, v99, v103
    s_nop 2
    v_add_f32 v5, v5, v6
    s_nop 1
    v_add_f32_dpp v5, v5, v5 quad_perm:[1,0,3,2] row_mask:0xf bank_mask:0xf
    s_nop 1
    v_add_f32_dpp v5, v5, v5 quad_perm:[2,3,0,1] row_mask:0xf bank_mask:0xf
    s_nop 1
    v_add_f32_dpp v5, v5, v5 row_half_mirror row_mask:0xf bank_mask:0xf
    v_mul_f32 v5, 0xbfb8aa3b, v5
    v_exp_f32 v5, v5
    v_lshlrev_b32 v2, 2, v2
    v_add_f32 v5, 1.0, v5
    v_rcp_f32 v5, v5
    s_lshl_b32 s23, s24, 5
    s_add_u32 s23, s23, 12906496
    buffer_store_dword v5, v2, s[28:31], s23 offen sc1
    s_branch H_MID
H_FNET:
    s_cmp_lt_u32 s22, 44
    s_cbranch_scc1 H_FN_A
    s_sub_u32 s24, s22, 44
    s_lshl_b32 s24, s24, 3
    s_add_u32 s24, s24, s17
    s_cmp_ge_u32 s24, 11
    s_cbranch_scc1 H_MID
    s_mov_b32 s23, 32
    s_branch H_FN_B
H_FN_A:
    s_mul_i32 s23, s22, 5958
    s_lshr_b32 s23, s23, 16
    s_mul_i32 s24, s23, 11
    s_sub_u32 s24, s22, s24
    s_lshl_b32 s23, s23, 3
    s_add_u32 s23, s23, s17
H_FN_B:
    s_and_b32 s25, s23, 1
    s_add_u32 s26, s24, 10
    s_cmp_eq_u32 s24, 10
    s_cselect_b32 s26, 10, s26
    s_cmp_eq_u32 s39, 0
    s_cselect_b32 s26, s24, s26
    s_mul_i32 s32, s26, 52
    s_lshr_b32 s32, s32, 8
    s_lshl_b32 s32, s32, 13
    s_add_u32 s32, s32, 6144
    s_and_b32 s34, s23, 31
    s_lshl_b32 s34, s34, 8
    s_mov_b64 exec, 0xffff
    v_add_u32 v2, s32, v126
    s_mov_b32 exec_lo, 0xff0000
    v_add_u32 v2, s34, v127
    s_mov_b32 s27, 15536128
    s_mov_b64 exec, 0xffffff
    s_mov_b32 s60, 0
    s_branch L_POLLE7
L_POLL7:
    s_sleep 8
L_POLLE7:
    buffer_load_dwordx4 v[4:7], v2, s[28:31], s27 offen sc1
    s_add_u32 s60, s60, 1
    s_waitcnt vmcnt(0)
    v_min3_u32 v4, v4, v5, v6
    s_cmp_lt_u32 s60, 0x40000
    v_min_u32 v4, v4, v7
    s_cbranch_scc0 L_POLLD7
    v_cmp_eq_u32 vcc, 0, v4
    s_cbranch_vccnz L_POLL7
L_POLLD7:
    s_mov_b64 exec, -1
    s_lshl_b32 s32, s23, 16
    s_lshl_b32 s27, s39, 10
    s_add_u32 s32, s32, s27
    s_add_u32 s32, s32, 9211904
    s_mul_i32 s27, s25, 655360
    s_lshl_b32 s33, s26, 15
    s_add_u32 s33, s33, s27
    s_add_u32 s33, s33, 7897088
    s_lshl_b32 s35, s26, 7
    s_add_u32 s35, s35, 9207808
    buffer_load_dwordx4 v[0:3], v125, s[28:31], s35 offen offset:0 sc1
    buffer_load_dwordx4 v[4:7], v125, s[28:31], s35 offen offset:32 sc1
    buffer_load_dwordx4 v[8:11], v125, s[28:31], s35 offen offset:64 sc1
    buffer_load_dwordx4 v[12:15], v125, s[28:31], s35 offen offset:96 sc1
    buffer_load_dwordx4 v[16:19], v128, s[28:31], s33 offen offset:0 sc1
    buffer_load_dwordx4 v[20:23], v129, s[28:31], s32 offen offset:0 sc1
    buffer_load_dwordx4 v[24:27], v128, s[28:31], s33 offen offset:512 sc1
    buffer_load_dwordx4 v[28:31], v129, s[28:31], s32 offen offset:512 sc1
    s_add_u32 s32, s32, 4096
    buffer_load_dwordx4 v[32:35], v128, s[28:31], s33 offen offset:1024 sc1
    buffer_load_dwordx4 v[36:39], v129, s[28:31], s32 offen offset:0 sc1
    buffer_load_dwordx4 v[40:43], v128, s[28:31], s33 offen offset:1536 sc1
    buffer_load_dwordx4 v[44:47], v129, s[28:31], s32 offen offset:512 sc1
    s_add_u32 s32, s32, 4096
    buffer_load_dwordx4 v[48:51], v128, s[28:31], s33 offen offset:2048 sc1
    buffer_load_dwordx4 v[52:55], v129, s[28:31], s32 offen offset:0 sc1
    buffer_load_dwordx4 v[56:59], v128, s[28:31], s33 offen offset:2560 sc1
    buffer_load_dwordx4 v[60:63], v129, s[28:31], s32 offen offset:512 sc1
    s_add_u32 s32, s32, 4096
    buffer_load_dwordx4 v[64:67], v128, s[28:31], s33 offen offset:3072 sc1
    buffer_load_dwordx4 v[68:71], v129, s[28:31], s32 offen offset:0 sc1
    buffer_load_dwordx4 v[72:75], v128, s[28:31], s33 offen offset:3584 sc1
    buffer_load_dwordx4 v[76:79], v129, s[28:31], s32 offen offset:512 sc1
    s_add_u32 s32, s32, 4096
    s_add_u32 s33, s33, 4096
    s_cmp_eq_u32 s25, s39
    s_cselect_b32 s36, 1.0, 0
    v_or_b32 v160, s36, v124
    s_waitcnt vmcnt(16)
    v_pk_mul_f32 v[0:1], v[0:1], v[160:161] op_sel_hi:[1,0]
    v_pk_mul_f32 v[2:3], v[2:3], v[160:161] op_sel_hi:[1,0]
    v_pk_mul_f32 v[4:5], v[4:5], v[160:161] op_sel_hi:[1,0]
    v_pk_mul_f32 v[6:7], v[6:7], v[160:161] op_sel_hi:[1,0]
    v_pk_mul_f32 v[8:9], v[8:9], v[160:161] op_sel_hi:[1,0]
    v_pk_mul_f32 v[10:11], v[10:11], v[160:161] op_sel_hi:[1,0]
    v_pk_mul_f32 v[12:13], v[12:13], v[160:161] op_sel_hi:[1,0]
    v_pk_mul_f32 v[14:15], v[14:15], v[160:161] op_sel_hi:[1,0]
    s_setprio 2
    s_mov_b32 s38, 0
H_FN_LOOP:
    s_waitcnt vmcnt(14)
    v_mfma_f32_32x32x16_bf16 v[0:15], v[16:19], v[20:23], v[0:15]
    buffer_load_dwordx4 v[16:19], v128, s[28:31], s33 offen offset:0 sc1
    buffer_load_dwordx4 v[20:23], v129, s[28:31], s32 offen offset:0 sc1
    s_waitcnt vmcnt(14)
    v_mfma_f32_32x32x16_bf16 v[0:15], v[24:27], v[28:31], v[0:15]
    buffer_load_dwordx4 v[24:27], v128, s[28:31], s33 offen offset:512 sc1
    buffer_load_dwordx4 v[28:31], v129, s[28:31], s32 offen offset:512 sc1
    s_add_u32 s32, s32, 4096
    s_waitcnt vmcnt(14)
    v_mfma_f32_32x32x16_bf16 v[0:15], v[32:35], v[36:39], v[0:15]
    buffer_load_dwordx4 v[32:35], v128, s[28:31], s33 offen offset:1024 sc1
    buffer_load_dwordx4 v[36:39], v129, s[28:31], s32 offen offset:0 sc1
    s_waitcnt vmcnt(14)
    v_mfma_f32_32x32x16_bf16 v[0:15], v[40:43], v[44:47], v[0:15]
    buffer_load_dwordx4 v[40:43], v128, s[28:31], s33 offen offset:1536 sc1
    buffer_load_dwordx4 v[44:47], v129, s[28:31], s32 offen offset:512 sc1
    s_add_u32 s32, s32, 4096
    s_waitcnt vmcnt(14)
    v_mfma_f32_32x32x16_bf16 v[0:15], v[48:51], v[52:55], v[0:15]
    buffer_load_dwordx4 v[48:51], v128, s[28:31], s33 offen offset:2048 sc1
    buffer_load_dwordx4 v[52:55], v129, s[28:31], s32 offen offset:0 sc1
    s_waitcnt vmcnt(14)
    v_mfma_f32_32x32x16_bf16 v[0:15], v[56:59], v[60:63], v[0:15]
    buffer_load_dwordx4 v[56:59], v128, s[28:31], s33 offen offset:2560 sc1
    buffer_load_dwordx4 v[60:63], v129, s[28:31], s32 offen offset:512 sc1
    s_add_u32 s32, s32, 4096
    s_waitcnt vmcnt(14)
    v_mfma_f32_32x32x16_bf16 v[0:15], v[64:67], v[68:71], v[0:15]
    buffer_load_dwordx4 v[64:67], v128, s[28:31], s33 offen offset:3072 sc1
    buffer_load_dwordx4 v[68:71], v129, s[28:31], s32 offen offset:0 sc1
    s_waitcnt vmcnt(14)
    v_mfma_f32_32x32x16_bf16 v[0:15], v[72:75], v[76:79], v[0:15]
    buffer_load_dwordx4 v[72:75], v128, s[28:31], s33 offen offset:3584 sc1
    buffer_load_dwordx4 v[76:79], v129, s[28:31], s32 offen offset:512 sc1
    s_add_u32 s32, s32, 4096
    s_add_u32 s33, s33, 4096
    s_add_u32 s38, s38, 1
    s_cmp_lt_u32 s38, 3
    s_cbranch_scc1 H_FN_LOOP
    s_waitcnt vmcnt(14)
    v_mfma_f32_32x32x16_bf16 v[0:15], v[16:19], v[20:23], v[0:15]
    s_waitcnt vmcnt(12)
    v_mfma_f32_32x32x16_bf16 v[0:15], v[24:27], v[28:31], v[0:15]
    s_waitcnt vmcnt(10)
    v_mfma_f32_32x32x16_bf16 v[0:15], v[32:35], v[36:39], v[0:15]
    s_waitcnt vmcnt(8)
    v_mfma_f32_32x32x16_bf16 v[0:15], v[40:43], v[44:47], v[0:15]
    s_waitcnt vmcnt(6)
    v_mfma_f32_32x32x16_bf16 v[0:15], v[48:51], v[52:55], v[0:15]
    s_waitcnt vmcnt(4)
    v_mfma_f32_32x32x16_bf16 v[0:15], v[56:59], v[60:63], v[0:15]
    s_waitcnt vmcnt(2)
    v_mfma_f32_32x32x16_bf16 v[0:15], v[64:67], v[68:71], v[0:15]
    s_waitcnt vmcnt(0)
    v_mfma_f32_32x32x16_bf16 v[0:15], v[72:75], v[76:79], v[0:15]
    s_setprio 3
    s_mov_b64 exec, 255
    s_branch L_LWE8
L_LW8:
    s_sleep 8
L_LWE8:
    ds_read_b32 v133, v120
    s_waitcnt lgkmcnt(0)
    v_cmp_gt_u32 vcc, 2, v133
    s_cbranch_vccnz L_LW8
    s_mov_b64 exec, -1
    s_lshl_b32 s27, s16, 11
    s_add_u32 s27, s27, 5120
    v_add_u32 v132, s27, v163
    s_xor_b32 s27, s16, 1
    s_lshl_b32 s36, s27, 11
    s_add_u32 s36, s36, 5120
    v_add_u32 v133, s36, v163
    s_lshl_b32 s27, s27, 2
    s_add_u32 s27, s27, 158848
    v_mov_b32 v134, s27
    v_xor_b32 v135, 4, v134
    s_mul_i32 s34, s24, 139264
    s_mul_i32 s27, s25, 8704
    s_add_u32 s34, s34, s27
    s_lshr_b32 s27, s23, 1
    s_lshl_b32 s27, s27, 9
    s_add_u32 s34, s34, s27
    s_mul_i32 s27, s39, 69632
    s_add_u32 s34, s34, s27
    s_add_u32 s34, s34, 11374592
    s_add_u32 s35, s34, 34816
    s_cmp_eq_u32 s39, 0
    s_cbranch_scc1 H_FX0
    s_cmp_eq_u32 s26, 10
    s_cselect_b32 s44, -1, 0
    s_mov_b32 s45, 0
    v_cndmask_b32 v0, v0, 0, s[44:45]
    ds_write_b128 v132, v[0:3]
    ds_write_b128 v132, v[4:7] offset:1024
    s_branch H_FX1
H_FX0:
    ds_write_b128 v132, v[8:11]
    ds_write_b128 v132, v[12:15] offset:1024
H_FX1:
    ds_write_b32 v135, v121
H_FX2:
    ds_read_b32 v136, v134
    ds_read_b128 v[80:83], v133
    ds_read_b128 v[84:87], v133 offset:1024
    s_waitcnt lgkmcnt(0)
    v_cmp_eq_u32 vcc, 0, v136
    s_cbranch_vccz H_FX3
    s_sleep 4
    s_branch H_FX2
H_FX3:
    s_cmp_eq_u32 s39, 0
    s_cbranch_scc1 H_FX4
    v_pk_add_f32 v[16:17], v[80:81], v[8:9]
    v_pk_add_f32 v[24:25], v[80:81], v[8:9] neg_lo:[0,1] neg_hi:[0,1]
    v_pk_add_f32 v[18:19], v[82:83], v[10:11]
    v_pk_add_f32 v[26:27], v[82:83], v[10:11] neg_lo:[0,1] neg_hi:[0,1]
    v_pk_add_f32 v[20:21], v[84:85], v[12:13]
    v_pk_add_f32 v[28:29], v[84:85], v[12:13] neg_lo:[0,1] neg_hi:[0,1]
    v_pk_add_f32 v[22:23], v[86:87], v[14:15]
    v_pk_add_f32 v[30:31], v[86:87], v[14:15] neg_lo:[0,1] neg_hi:[0,1]
    s_branch H_FX5
H_FX4:
    v_pk_add_f32 v[16:17], v[0:1], v[80:81]
    v_pk_add_f32 v[24:25], v[0:1], v[80:81] neg_lo:[0,1] neg_hi:[0,1]
    v_pk_add_f32 v[18:19], v[2:3], v[82:83]
    v_pk_add_f32 v[26:27], v[2:3], v[82:83] neg_lo:[0,1] neg_hi:[0,1]
    v_pk_add_f32 v[20:21], v[4:5], v[84:85]
    v_pk_add_f32 v[28:29], v[4:5], v[84:85] neg_lo:[0,1] neg_hi:[0,1]
    v_pk_add_f32 v[22:23], v[6:7], v[86:87]
    v_pk_add_f32 v[30:31], v[6:7], v[86:87] neg_lo:[0,1] neg_hi:[0,1]
H_FX5:
    v_cvt_pk_bf16_f32 v16, v16, v24
    v_cvt_pk_bf16_f32 v17, v17, v25
    v_cvt_pk_bf16_f32 v18, v18, v26
    v_cvt_pk_bf16_f32 v19, v19, v27
    v_cvt_pk_bf16_f32 v20, v20, v28
    v_cvt_pk_bf16_f32 v21, v21, v29
    v_cvt_pk_bf16_f32 v22, v22, v30
    v_cvt_pk_bf16_f32 v23, v23, v31
    buffer_store_dwordx4 v[16:19], v123, s[28:31], s34 offen sc1
    buffer_store_dwordx4 v[20:23], v123, s[28:31], s35 offen sc1
H_MID:
    s_setprio 3
    s_lshl_b32 s19, s17, 2
    s_and_b32 s20, s18, 3
    s_add_u32 s19, s19, s20
    s_lshr_b32 s20, s18, 2
    s_mov_b32 s32, s50
    s_mov_b32 s33, s51
    s_mov_b32 s34, 819200
    s_mov_b32 s35, 0x20000
    s_mov_b32 s36, s54
    s_mov_b32 s37, s55
    s_mov_b32 s38, 2621440
    s_mov_b32 s39, 0x20000
    s_mul_i32 s26, s20, 160
    s_mul_i32 s27, s16, 204800
    s_add_u32 s27, s27, s26
    s_movk_i32 s23, 1120
    s_add_u32 s25, s16, 1
    s_and_b32 s25, s25, 3
    s_mul_i32 s22, s25, 25600
    s_add_u32 s22, s22, 5120
    s_add_u32 s25, s25, 3
    s_waitcnt vmcnt(0)
    s_mov_b64 exec, 255
    s_branch L_LWE9
L_LW9:
    s_sleep 8
L_LWE9:
    ds_read_b32 v133, v120
    s_waitcnt lgkmcnt(0)
    v_cmp_gt_u32 vcc, 3, v133
    s_cbranch_vccnz L_LW9
    s_mov_b64 exec, -1
    s_mov_b64 exec, 1
    ds_add_rtn_u32 v133, v120, v121 offset:48
    s_waitcnt lgkmcnt(0)
    v_cmp_eq_u32 vcc, 3, v133
    s_cbranch_vccz H_NOY
    buffer_store_dword v121, v122, s[28:31], 0 offen sc1
H_NOY:
    s_mov_b64 exec, -1
    s_mov_b64 exec, 255
    s_branch L_LWE10
L_LW10:
    s_sleep 8
L_LWE10:
    ds_read_b32 v133, v120
    s_waitcnt lgkmcnt(0)
    v_cmp_gt_u32 vcc, s25, v133
    s_cbranch_vccnz L_LW10
    s_mov_b64 exec, -1
    s_cmp_lg_u32 s16, 3
    s_cbranch_scc1 H_NX
    v_add_u32 v132, 48, v120
    s_mov_b64 exec, 1
    s_branch L_LWE11
L_LW11:
    s_sleep 8
L_LWE11:
    ds_read_b32 v133, v132
    s_waitcnt lgkmcnt(0)
    v_cmp_gt_u32 vcc, 4, v133
    s_cbranch_vccnz L_LW11
    s_mov_b64 exec, -1
H_NX:
    s_mov_b32 s25, 0
H_WO:
    s_add_u32 m0, s22, 0
    s_nop 0
    buffer_load_dwordx4 v112, s[32:35], s27 offen lds
    s_add_u32 m0, s22, 1024
    s_nop 0
    buffer_load_dwordx4 v113, s[32:35], s27 offen lds
    s_add_u32 m0, s22, 2048
    s_nop 0
    buffer_load_dwordx4 v114, s[32:35], s27 offen lds
    s_add_u32 m0, s22, 3072
    s_nop 0
    buffer_load_dwordx4 v115, s[32:35], s27 offen lds
    s_add_u32 m0, s22, 4096
    s_nop 0
    buffer_load_dwordx4 v116, s[32:35], s27 offen lds
    s_add_u32 s22, s22, 5120
    s_add_u32 s27, s27, 40960
    s_add_u32 s25, s25, 1
    s_cmp_lt_u32 s25, 5
    s_cbranch_scc1 H_WO
    s_cmp_lg_u32 s16, 3
    s_cbranch_scc1 H_YW
    s_mov_b64 exec, 255
    s_branch L_LWE12
L_LW12:
    s_sleep 16
L_LWE12:
    ds_read_b32 v133, v120
    s_waitcnt lgkmcnt(0)
    v_cmp_gt_u32 vcc, 5, v133
    s_cbranch_vccnz L_LW12
    s_mov_b64 exec, -1
    s_mov_b32 s27, 15568896
    s_mov_b64 exec, -1
    s_mov_b32 s60, 0
    s_branch L_POLLE13
L_POLL13:
    s_sleep 16
L_POLLE13:
    buffer_load_dwordx4 v[4:7], v126, s[28:31], s27 offen sc1
    s_add_u32 s60, s60, 1
    s_waitcnt vmcnt(0)
    v_min3_u32 v4, v4, v5, v6
    s_cmp_lt_u32 s60, 0x40000
    v_min_u32 v4, v4, v7
    s_cbranch_scc0 L_POLLD13
    v_cmp_eq_u32 vcc, 0, v4
    s_cbranch_vccnz L_POLL13
L_POLLD13:
    s_mov_b64 exec, -1
    s_mov_b64 exec, 1
    ds_add_u32 v120, v121 offset:40
    s_mov_b64 exec, -1
H_YW:
    v_add_u32 v132, 40, v120
    s_mov_b64 exec, 1
    s_branch L_LWE14
L_LW14:
    s_sleep 16
L_LWE14:
    ds_read_b32 v133, v132
    s_waitcnt lgkmcnt(0)
    v_cmp_gt_u32 vcc, 1, v133
    s_cbranch_vccnz L_LW14
    s_mov_b64 exec, -1
    s_waitcnt vmcnt(0)
    v_mov_b32 v132, 2
    s_mov_b64 exec, 1
    ds_add_u32 v120, v132 offset:32
    s_mov_b64 exec, -1
    s_mov_b32 s26, 11374592
    s_mov_b32 s27, 12906496
    buffer_load_dword v167, v117, s[28:31], s27 offen sc1
    buffer_load_dwordx4 v[40:43], v118, s[28:31], s26 offen sc1
    s_add_u32 s26, s26, 17408
    buffer_load_dwordx4 v[44:47], v118, s[28:31], s26 offen sc1
    s_add_u32 s26, s26, 17408
    buffer_load_dwordx4 v[48:51], v118, s[28:31], s26 offen sc1
    s_add_u32 s26, s26, 17408
    buffer_load_dwordx4 v[52:55], v118, s[28:31], s26 offen sc1
    s_add_u32 s26, s26, 17408
    buffer_load_dwordx4 v[56:59], v118, s[28:31], s26 offen sc1
    s_add_u32 s26, s26, 17408
    buffer_load_dwordx4 v[60:63], v118, s[28:31], s26 offen sc1
    s_add_u32 s26, s26, 17408
    s_waitcnt vmcnt(0)
    s_cmp_ge_u32 s20, 4
    s_cbranch_scc1 H_DESC
    v_perm_b32 v150, v41, v40, v119
    v_perm_b32 v151, v43, v42, v119
    v_perm_b32 v152, v45, v44, v119
    v_perm_b32 v153, v47, v46, v119
    v_perm_b32 v154, v49, v48, v119
    v_perm_b32 v155, v51, v50, v119
    v_perm_b32 v156, v53, v52, v119
    v_perm_b32 v157, v55, v54, v119
    v_perm_b32 v158, v57, v56, v119
    v_perm_b32 v159, v59, v58, v119
    s_branch H_UNP
H_DESC:
    v_perm_b32 v150, v59, v60, v119
    v_perm_b32 v151, v57, v58, v119
    v_perm_b32 v152, v55, v56, v119
    v_perm_b32 v153, v53, v54, v119
    v_perm_b32 v154, v51, v52, v119
    v_perm_b32 v155, v49, v50, v119
    v_perm_b32 v156, v47, v48, v119
    v_perm_b32 v157, v45, v46, v119
    v_perm_b32 v158, v43, v44, v119
    v_perm_b32 v159, v41, v42, v119
H_UNP:
    s_mov_b64 exec, 15
    s_branch L_LWE15
L_LW15:
    s_sleep 8
L_LWE15:
    ds_read_b32 v8, v120
    s_waitcnt lgkmcnt(0)
    v_cmp_gt_u32 vcc, 8, v8
    s_cbranch_vccnz L_LW15
    s_mov_b64 exec, -1
    s_mov_b32 s41, s16
    s_mov_b32 s47, 0
P3_GO:
    s_setprio 0
    s_lshl_b32 s22, s17, 3
    s_and_b32 s23, s18, 3
    s_add_u32 s22, s22, s23
    s_lshl_b32 s22, s22, 1
    s_add_u32 s22, s22, s47
    s_mul_i32 s22, s22, 20480
    s_add_u32 s22, s22, 12914688
    s_lshl_b32 s44, s41, 12
    s_add_u32 s44, s44, s22
    s_lshl_b32 s45, s41, 10
    s_add_u32 s45, s45, s22
    s_add_u32 s45, s45, 16384
    s_lshl_b32 s46, s47, 2
    s_add_u32 s40, s46, 158800
    s_add_u32 s46, s46, s41
    s_mul_i32 s46, s46, 5120
    s_add_u32 s46, s46, 5120
    s_mov_b32 s26, 0
    s_mov_b32 s42, 0
    v_mov_b32 v160, 158752
    s_mov_b64 exec, 1
    s_branch L_LWE16
L_LW16:
    s_sleep 8
L_LWE16:
    ds_read_b32 v161, v160
    s_waitcnt lgkmcnt(0)
    v_cmp_gt_u32 vcc, 8, v161
    s_cbranch_vccnz L_LW16
    s_mov_b64 exec, -1
P3_TRY:
    buffer_load_dwordx4 v[100:103], v163, s[28:31], s44 offen offset:0 sc1
    buffer_load_dwordx4 v[104:107], v163, s[28:31], s44 offen offset:1024 sc1
    buffer_load_dwordx4 v[108:111], v163, s[28:31], s44 offen offset:2048 sc1
    buffer_load_dwordx4 v[112:115], v163, s[28:31], s44 offen offset:3072 sc1
    buffer_load_dwordx2 v[116:117], v164, s[28:31], s45 offen sc1
    buffer_load_dwordx2 v[118:119], v164, s[28:31], s45 offen offset:128 sc1
    s_cmp_lg_u32 s26, 0
    s_cbranch_scc1 P3_CHK
    s_add_u32 s23, s41, 1
    s_and_b32 s23, s23, 3
    s_mul_i32 s23, s23, 25600
    s_add_u32 s23, s23, 5120
    v_add_u32 v160, s23, v165
    v_add_u32 v161, s23, v166
    ds_read_b64_tr_b16 v[0:1], v160 offset:0
    ds_read_b64_tr_b16 v[2:3], v160 offset:1280
    ds_read_b64_tr_b16 v[4:5], v160 offset:8
    ds_read_b64_tr_b16 v[6:7], v160 offset:1288
    ds_read_b64_tr_b16 v[8:9], v160 offset:16
    ds_read_b64_tr_b16 v[10:11], v160 offset:1296
    ds_read_b64_tr_b16 v[12:13], v160 offset:24
    ds_read_b64_tr_b16 v[14:15], v160 offset:1304
    ds_read_b64_tr_b16 v[16:17], v160 offset:32
    ds_read_b64_tr_b16 v[18:19], v160 offset:1312
    ds_read_b64_tr_b16 v[20:21], v160 offset:6400
    ds_read_b64_tr_b16 v[22:23], v160 offset:7680
    ds_read_b64_tr_b16 v[24:25], v160 offset:6408
    ds_read_b64_tr_b16 v[26:27], v160 offset:7688
    ds_read_b64_tr_b16 v[28:29], v160 offset:6416
    ds_read_b64_tr_b16 v[30:31], v160 offset:7696
    ds_read_b64_tr_b16 v[32:33], v160 offset:6424
    ds_read_b64_tr_b16 v[34:35], v160 offset:7704
    ds_read_b64_tr_b16 v[36:37], v160 offset:6432
    ds_read_b64_tr_b16 v[38:39], v160 offset:7712
    ds_read_b64_tr_b16 v[40:41], v160 offset:12800
    ds_read_b64_tr_b16 v[42:43], v160 offset:14080
    ds_read_b64_tr_b16 v[44:45], v160 offset:12808
    ds_read_b64_tr_b16 v[46:47], v160 offset:14088
    ds_read_b64_tr_b16 v[48:49], v160 offset:12816
    ds_read_b64_tr_b16 v[50:51], v160 offset:14096
    ds_read_b64_tr_b16 v[52:53], v160 offset:12824
    ds_read_b64_tr_b16 v[54:55], v160 offset:14104
    ds_read_b64_tr_b16 v[56:57], v160 offset:12832
    ds_read_b64_tr_b16 v[58:59], v160 offset:14112
    ds_read_b64_tr_b16 v[60:61], v160 offset:19200
    ds_read_b64_tr_b16 v[62:63], v160 offset:20480
    ds_read_b64_tr_b16 v[64:65], v160 offset:19208
    ds_read_b64_tr_b16 v[66:67], v160 offset:20488
    ds_read_b64_tr_b16 v[68:69], v160 offset:19216
    ds_read_b64_tr_b16 v[70:71], v160 offset:20496
    ds_read_b64_tr_b16 v[72:73], v160 offset:19224
    ds_read_b64_tr_b16 v[74:75], v160 offset:20504
    ds_read_b64_tr_b16 v[76:77], v160 offset:19232
    ds_read_b64_tr_b16 v[78:79], v160 offset:20512
    ds_read_b64_tr_b16 v[80:81], v161 offset:0
    ds_read_b64_tr_b16 v[82:83], v161 offset:3200
    ds_read_b64_tr_b16 v[84:85], v161 offset:8
    ds_read_b64_tr_b16 v[86:87], v161 offset:3208
    ds_read_b64_tr_b16 v[88:89], v161 offset:16
    ds_read_b64_tr_b16 v[90:91], v161 offset:3216
    ds_read_b64_tr_b16 v[92:93], v161 offset:24
    ds_read_b64_tr_b16 v[94:95], v161 offset:3224
    ds_read_b64_tr_b16 v[96:97], v161 offset:32
    ds_read_b64_tr_b16 v[98:99], v161 offset:3232
    v_mov_b32 v165, 158756
    v_mov_b32 v166, 1
    s_waitcnt lgkmcnt(0)
    s_mov_b64 exec, 1
    ds_add_u32 v165, v166 offset:0
    s_mov_b64 exec, -1
P3_CHK:
    s_add_u32 s26, s26, 1
    s_mov_b32 s43, -1
P3_C0:
    s_waitcnt vmcnt(5)
    v_max3_u32 v160, v100, v101, v102
    v_max3_u32 v160, v103, v160, 1
    v_cmp_eq_u32 vcc, s43, v160
    s_cbranch_vccnz P3_B0
    v_mfma_f32_16x16x32_bf16 v[120:123], v[0:3], v[100:103], 0
    v_mfma_f32_16x16x32_bf16 v[124:127], v[4:7], v[100:103], 0
    v_mfma_f32_16x16x32_bf16 v[128:131], v[8:11], v[100:103], 0
    v_mfma_f32_16x16x32_bf16 v[132:135], v[12:15], v[100:103], 0
    v_mfma_f32_16x16x32_bf16 v[136:139], v[16:19], v[100:103], 0
P3_C1:
    s_waitcnt vmcnt(4)
    v_max3_u32 v160, v104, v105, v106
    v_max3_u32 v160, v107, v160, 1
    v_cmp_eq_u32 vcc, s43, v160
    s_cbranch_vccnz P3_B1
    v_mfma_f32_16x16x32_bf16 v[120:123], v[20:23], v[104:107], v[120:123]
    v_mfma_f32_16x16x32_bf16 v[124:127], v[24:27], v[104:107], v[124:127]
    v_mfma_f32_16x16x32_bf16 v[128:131], v[28:31], v[104:107], v[128:131]
    v_mfma_f32_16x16x32_bf16 v[132:135], v[32:35], v[104:107], v[132:135]
    v_mfma_f32_16x16x32_bf16 v[136:139], v[36:39], v[104:107], v[136:139]
P3_C2:
    s_waitcnt vmcnt(3)
    v_max3_u32 v160, v108, v109, v110
    v_max3_u32 v160, v111, v160, 1
    v_cmp_eq_u32 vcc, s43, v160
    s_cbranch_vccnz P3_B2
    v_mfma_f32_16x16x32_bf16 v[120:123], v[40:43], v[108:111], v[120:123]
    v_mfma_f32_16x16x32_bf16 v[124:127], v[44:47], v[108:111], v[124:127]
    v_mfma_f32_16x16x32_bf16 v[128:131], v[48:51], v[108:111], v[128:131]
    v_mfma_f32_16x16x32_bf16 v[132:135], v[52:55], v[108:111], v[132:135]
    v_mfma_f32_16x16x32_bf16 v[136:139], v[56:59], v[108:111], v[136:139]
P3_C3:
    s_waitcnt vmcnt(2)
    v_max3_u32 v160, v112, v113, v114
    v_max3_u32 v160, v115, v160, 1
    v_cmp_eq_u32 vcc, s43, v160
    s_cbranch_vccnz P3_B3
    v_mfma_f32_16x16x32_bf16 v[120:123], v[60:63], v[112:115], v[120:123]
    v_mfma_f32_16x16x32_bf16 v[124:127], v[64:67], v[112:115], v[124:127]
    v_mfma_f32_16x16x32_bf16 v[128:131], v[68:71], v[112:115], v[128:131]
    v_mfma_f32_16x16x32_bf16 v[132:135], v[72:75], v[112:115], v[132:135]
    v_mfma_f32_16x16x32_bf16 v[136:139], v[76:79], v[112:115], v[136:139]
P3_C4:
    s_waitcnt vmcnt(0)
    v_max3_u32 v160, v116, v117, v118
    v_max3_u32 v160, v119, v160, 1
    v_cmp_eq_u32 vcc, s43, v160
    s_cbranch_vccnz P3_B4
    v_mfma_f32_16x16x32_bf16 v[120:123], v[80:83], v[116:119], v[120:123]
    v_mfma_f32_16x16x32_bf16 v[124:127], v[84:87], v[116:119], v[124:127]
    v_mfma_f32_16x16x32_bf16 v[128:131], v[88:91], v[116:119], v[128:131]
    v_mfma_f32_16x16x32_bf16 v[132:135], v[92:95], v[116:119], v[132:135]
    v_mfma_f32_16x16x32_bf16 v[136:139], v[96:99], v[116:119], v[136:139]
    s_branch P3_OK
P3_B0:
    s_sleep 4
    buffer_load_dwordx4 v[100:103], v163, s[28:31], s44 offen offset:0 sc1
    buffer_load_dwordx4 v[104:107], v163, s[28:31], s44 offen offset:1024 sc1
    buffer_load_dwordx4 v[108:111], v163, s[28:31], s44 offen offset:2048 sc1
    buffer_load_dwordx4 v[112:115], v163, s[28:31], s44 offen offset:3072 sc1
    buffer_load_dwordx2 v[116:117], v164, s[28:31], s45 offen sc1
    buffer_load_dwordx2 v[118:119], v164, s[28:31], s45 offen offset:128 sc1
    s_add_u32 s26, s26, 1
    s_cmp_lt_u32 s26, 0x40000
    s_cselect_b32 s43, -1, 0
    s_branch P3_C0
P3_B1:
    s_sleep 4
    buffer_load_dwordx4 v[104:107], v163, s[28:31], s44 offen offset:1024 sc1
    buffer_load_dwordx4 v[108:111], v163, s[28:31], s44 offen offset:2048 sc1
    buffer_load_dwordx4 v[112:115], v163, s[28:31], s44 offen offset:3072 sc1
    buffer_load_dwordx2 v[116:117], v164, s[28:31], s45 offen sc1
    buffer_load_dwordx2 v[118:119], v164, s[28:31], s45 offen offset:128 sc1
    s_add_u32 s26, s26, 1
    s_cmp_lt_u32 s26, 0x40000
    s_cselect_b32 s43, -1, 0
    s_branch P3_C1
P3_B2:
    s_sleep 4
    buffer_load_dwordx4 v[108:111], v163, s[28:31], s44 offen offset:2048 sc1
    buffer_load_dwordx4 v[112:115], v163, s[28:31], s44 offen offset:3072 sc1
    buffer_load_dwordx2 v[116:117], v164, s[28:31], s45 offen sc1
    buffer_load_dwordx2 v[118:119], v164, s[28:31], s45 offen offset:128 sc1
    s_add_u32 s26, s26, 1
    s_cmp_lt_u32 s26, 0x40000
    s_cselect_b32 s43, -1, 0
    s_branch P3_C2
P3_B3:
    s_sleep 4
    buffer_load_dwordx4 v[112:115], v163, s[28:31], s44 offen offset:3072 sc1
    buffer_load_dwordx2 v[116:117], v164, s[28:31], s45 offen sc1
    buffer_load_dwordx2 v[118:119], v164, s[28:31], s45 offen offset:128 sc1
    s_add_u32 s26, s26, 1
    s_cmp_lt_u32 s26, 0x40000
    s_cselect_b32 s43, -1, 0
    s_branch P3_C3
P3_B4:
    s_sleep 4
    buffer_load_dwordx2 v[116:117], v164, s[28:31], s45 offen sc1
    buffer_load_dwordx2 v[118:119], v164, s[28:31], s45 offen offset:128 sc1
    s_add_u32 s26, s26, 1
    s_cmp_lt_u32 s26, 0x40000
    s_cselect_b32 s43, -1, 0
    s_branch P3_C4
P3_OK:
    s_cmp_lg_u32 s42, 0
    s_cbranch_scc1 P3_WR
    s_mov_b64 exec, 1
    s_branch L_LWE17
L_LW17:
    s_sleep 2
L_LWE17:
    ds_read_b32 v161, v165
    s_waitcnt lgkmcnt(0)
    v_cmp_gt_u32 vcc, 8, v161
    s_cbranch_vccnz L_LW17
    s_mov_b64 exec, -1
P3_WR:
    v_add_u32 v160, s46, v163
    v_mov_b32 v161, s40
    s_nop 1
    ds_write_b128 v160, v[120:123] offset:0
    ds_write_b128 v160, v[124:127] offset:1024
    ds_write_b128 v160, v[128:131] offset:2048
    ds_write_b128 v160, v[132:135] offset:3072
    ds_write_b128 v160, v[136:139] offset:4096
    s_waitcnt lgkmcnt(0)
    s_mov_b64 exec, 1
    ds_add_u32 v161, v166 offset:0
    s_mov_b64 exec, -1
    s_add_u32 s44, s44, 163840
    s_add_u32 s45, s45, 163840
    s_add_u32 s46, s46, 40960
    s_add_u32 s40, s40, 8
    s_add_u32 s42, s42, 1
    s_cmp_ge_u32 s42, 2
    s_cbranch_scc1 P3_END
    s_cmp_ge_u32 s16, 4
    s_cbranch_scc1 P3_TRY
    v_lshlrev_b32 v140, 16, v150
    v_and_b32 v141, 0xffff0000, v150
    v_lshlrev_b32 v142, 16, v151
    v_and_b32 v143, 0xffff0000, v151
    v_lshlrev_b32 v144, 16, v152
    v_and_b32 v145, 0xffff0000, v152
    v_lshlrev_b32 v146, 16, v153
    v_and_b32 v147, 0xffff0000, v153
    v_lshlrev_b32 v148, 16, v154
    v_and_b32 v149, 0xffff0000, v154
    v_lshlrev_b32 v150, 16, v155
    v_and_b32 v151, 0xffff0000, v155
    v_lshlrev_b32 v152, 16, v156
    v_and_b32 v153, 0xffff0000, v156
    v_lshlrev_b32 v154, 16, v157
    v_and_b32 v155, 0xffff0000, v157
    v_lshlrev_b32 v156, 16, v158
    v_and_b32 v157, 0xffff0000, v158
    v_lshlrev_b32 v158, 16, v159
    v_and_b32 v159, 0xffff0000, v159
    v_mul_f32 v140, v140, v167
    v_mul_f32 v141, v141, v167
    v_mul_f32 v142, v142, v167
    v_mul_f32 v143, v143, v167
    v_mul_f32 v144, v144, v167
    v_mul_f32 v145, v145, v167
    v_mul_f32 v146, v146, v167
    v_mul_f32 v147, v147, v167
    v_mul_f32 v148, v148, v167
    v_mul_f32 v149, v149, v167
    v_mul_f32 v150, v150, v167
    v_mul_f32 v151, v151, v167
    v_mul_f32 v152, v152, v167
    v_mul_f32 v153, v153, v167
    v_mul_f32 v154, v154, v167
    v_mul_f32 v155, v155, v167
    v_mul_f32 v156, v156, v167
    v_mul_f32 v157, v157, v167
    v_mul_f32 v158, v158, v167
    v_mul_f32 v159, v159, v167
    v_sub_f32 v167, 1.0, v167
    s_branch P3_TRY
P3_END:
    s_cmp_ge_u32 s16, 4
    s_cbranch_scc1 L_END
    s_setprio 3
    s_lshl_b32 s23, s16, 2
    s_add_u32 s23, s23, 158800
    v_mov_b32 v161, s23
    s_mul_i32 s23, s16, 20480
    s_add_u32 s23, s23, 5120
    v_add_u32 v160, s23, v163
    s_mov_b64 exec, 1
    s_branch L_LWE18
L_LW18:
    s_sleep 1
L_LWE18:
    ds_read_b32 v165, v161
    s_waitcnt lgkmcnt(0)
    v_cmp_gt_u32 vcc, 4, v165
    s_cbranch_vccnz L_LW18
    s_mov_b64 exec, -1
    ds_read_b128 v[0:3], v160 offset:0
    ds_read_b128 v[4:7], v160 offset:5120
    ds_read_b128 v[8:11], v160 offset:10240
    ds_read_b128 v[12:15], v160 offset:15360
    ds_read_b128 v[16:19], v160 offset:1024
    ds_read_b128 v[20:23], v160 offset:6144
    ds_read_b128 v[24:27], v160 offset:11264
    ds_read_b128 v[28:31], v160 offset:16384
    ds_read_b128 v[32:35], v160 offset:2048
    ds_read_b128 v[36:39], v160 offset:7168
    ds_read_b128 v[40:43], v160 offset:12288
    ds_read_b128 v[44:47], v160 offset:17408
    ds_read_b128 v[48:51], v160 offset:3072
    ds_read_b128 v[52:55], v160 offset:8192
    ds_read_b128 v[56:59], v160 offset:13312
    ds_read_b128 v[60:63], v160 offset:18432
    ds_read_b128 v[64:67], v160 offset:4096
    ds_read_b128 v[68:71], v160 offset:9216
    ds_read_b128 v[72:75], v160 offset:14336
    ds_read_b128 v[76:79], v160 offset:19456
    s_waitcnt lgkmcnt(15)
    v_pk_add_f32 v[0:1], v[0:1], v[4:5]
    v_pk_add_f32 v[8:9], v[8:9], v[12:13]
    v_pk_add_f32 v[2:3], v[2:3], v[6:7]
    v_pk_add_f32 v[10:11], v[10:11], v[14:15]
    v_pk_add_f32 v[0:1], v[0:1], v[8:9]
    v_pk_add_f32 v[2:3], v[2:3], v[10:11]
    v_fmac_f32 v140, v0, v167
    v_fmac_f32 v141, v1, v167
    v_fmac_f32 v142, v2, v167
    v_fmac_f32 v143, v3, v167
    v_cvt_pk_bf16_f32 v84, v140, v141
    v_cvt_pk_bf16_f32 v85, v142, v143
    s_waitcnt lgkmcnt(12)
    v_pk_add_f32 v[16:17], v[16:17], v[20:21]
    v_pk_add_f32 v[24:25], v[24:25], v[28:29]
    v_pk_add_f32 v[18:19], v[18:19], v[22:23]
    v_pk_add_f32 v[26:27], v[26:27], v[30:31]
    v_pk_add_f32 v[16:17], v[16:17], v[24:25]
    v_pk_add_f32 v[18:19], v[18:19], v[26:27]
    v_fmac_f32 v144, v16, v167
    v_fmac_f32 v145, v17, v167
    v_fmac_f32 v146, v18, v167
    v_fmac_f32 v147, v19, v167
    v_cvt_pk_bf16_f32 v86, v144, v145
    v_cvt_pk_bf16_f32 v87, v146, v147
    buffer_store_dwordx4 v[84:87], v162, s[36:39], 0 offen
    s_waitcnt lgkmcnt(8)
    v_pk_add_f32 v[32:33], v[32:33], v[36:37]
    v_pk_add_f32 v[40:41], v[40:41], v[44:45]
    v_pk_add_f32 v[34:35], v[34:35], v[38:39]
    v_pk_add_f32 v[42:43], v[42:43], v[46:47]
    v_pk_add_f32 v[32:33], v[32:33], v[40:41]
    v_pk_add_f32 v[34:35], v[34:35], v[42:43]
    v_fmac_f32 v148, v32, v167
    v_fmac_f32 v149, v33, v167
    v_fmac_f32 v150, v34, v167
    v_fmac_f32 v151, v35, v167
    v_cvt_pk_bf16_f32 v88, v148, v149
    v_cvt_pk_bf16_f32 v89, v150, v151
    s_waitcnt lgkmcnt(4)
    v_pk_add_f32 v[48:49], v[48:49], v[52:53]
    v_pk_add_f32 v[56:57], v[56:57], v[60:61]
    v_pk_add_f32 v[50:51], v[50:51], v[54:55]
    v_pk_add_f32 v[58:59], v[58:59], v[62:63]
    v_pk_add_f32 v[48:49], v[48:49], v[56:57]
    v_pk_add_f32 v[50:51], v[50:51], v[58:59]
    v_fmac_f32 v152, v48, v167
    v_fmac_f32 v153, v49, v167
    v_fmac_f32 v154, v50, v167
    v_fmac_f32 v155, v51, v167
    v_cvt_pk_bf16_f32 v90, v152, v153
    v_cvt_pk_bf16_f32 v91, v154, v155
    buffer_store_dwordx4 v[88:91], v162, s[36:39], 0 offen offset:16
    s_waitcnt lgkmcnt(0)
    v_pk_add_f32 v[64:65], v[64:65], v[68:69]
    v_pk_add_f32 v[72:73], v[72:73], v[76:77]
    v_pk_add_f32 v[66:67], v[66:67], v[70:71]
    v_pk_add_f32 v[74:75], v[74:75], v[78:79]
    v_pk_add_f32 v[64:65], v[64:65], v[72:73]
    v_pk_add_f32 v[66:67], v[66:67], v[74:75]
    v_fmac_f32 v156, v64, v167
    v_fmac_f32 v157, v65, v167
    v_fmac_f32 v158, v66, v167
    v_fmac_f32 v159, v67, v167
    v_cvt_pk_bf16_f32 v92, v156, v157
    v_cvt_pk_bf16_f32 v93, v158, v159
    buffer_store_dwordx2 v[92:93], v162, s[36:39], 0 offen offset:32
L_DONE:
L_END:
    s_endpgm
.fill 256, 4, 0xbf810000
L_CODE_END:
.section .rodata,"a"
.p2align 6
.amdhsa_kernel gated_mix__spectral_fnet__softmax_full_mha__prompt_kernel
  .amdhsa_next_free_vgpr 168
  .amdhsa_next_free_sgpr 64
  .amdhsa_accum_offset 168
  .amdhsa_group_segment_fixed_size 0
  .amdhsa_kernarg_size 96
  .amdhsa_user_sgpr_count 2
  .amdhsa_user_sgpr_kernarg_segment_ptr 1
  .amdhsa_system_sgpr_workgroup_id_x 1
.end_amdhsa_kernel
```
